```python
import torch

def _softmax(x, axis=-1):
    return torch.softmax(x, dim=axis)
def _gelu(x):
    return torch.nn.functional.gelu(x, approximate="tanh")
def _silu(x):
    return torch.nn.functional.silu(x)
def _sigmoid(x):
    return torch.sigmoid(x)
def _layernorm(x, axis=-1, eps=1e-5):
    m = x.mean(dim=axis, keepdim=True)
    v = x.var(dim=axis, keepdim=True, unbiased=False)
    return (x - m) / torch.sqrt(v + eps)
def _scatter_add(tgt, idx, src, axis=0):
    return tgt.clone().index_add_(axis, idx, src)
def _segment_sum(src, seg, n):
    out = torch.zeros((n,) + src.shape[1:], dtype=src.dtype)
    return out.index_add_(0, seg, src)
def _pad(x, pw):
    flat = tuple(v for pair in reversed(pw) for v in pair)
    return torch.nn.functional.pad(x, flat)

kernel_name = 'standalone__gqa_softmax__near_ridge'

def setup_inputs():

    _w = (lambda a: (lambda t: t.to(torch.bfloat16) if t.is_floating_point() else t)(torch.as_tensor(a)))
    B, Hq, Hkv, Sq, Sk, D = 8, 32, 16, 384, 384, 128
    return {
        "q": _w((lambda *s: torch.randn(*s, dtype=torch.bfloat16) * 0.8)(B, Hq, Sq, D)),
        "k": _w((lambda *s: torch.randn(*s, dtype=torch.bfloat16) * 0.8)(B, Hkv, Sk, D)),
        "v": _w((lambda *s: torch.randn(*s, dtype=torch.bfloat16) * 0.05)(B, Hkv, Sk, D)),
    }

def reference(q, k, v):
    B, Hq, Sq, D = q.shape
    Hkv = k.shape[1]
    rep = Hq // Hkv
    k = (lambda x, n, axis: torch.repeat_interleave(x, n, dim=axis))(k, rep, axis=1)
    v = (lambda x, n, axis: torch.repeat_interleave(x, n, dim=axis))(v, rep, axis=1)
    scale = D ** -0.5
    scores = torch.einsum("bhqd,bhkd->bhqk", q, k) * scale
    p = _softmax(scores, axis=-1)
    return torch.einsum("bhqk,bhkd->bhqd", p, v)
```

```asm
; @launch grid=(256,1,1) block=(256,1,1) lds=163840
.amdgcn_target "amdgcn-amd-amdhsa--gfx950"
.text
.globl standalone__gqa_softmax__near_ridge_kernel
.p2align 8
.type standalone__gqa_softmax__near_ridge_kernel,@function
standalone__gqa_softmax__near_ridge_kernel:
  s_cmp_ge_u32 s2, 256
  s_cbranch_scc1 L_end

  s_load_dwordx4 s[96:99], s[0:1], 0
  s_load_dwordx4 s[52:55], s[0:1], 16
  v_lshrrev_b32 v1, 6, v0
  s_getpc_b64 s[4:5]
L_pc:
  s_sub_u32 s4, s4, L_pc-standalone__gqa_softmax__near_ridge_kernel
  s_subb_u32 s5, s5, 0
  s_and_b32 s5, s5, 0xffff
  s_mov_b32 s6, L_slow-standalone__gqa_softmax__near_ridge_kernel
  s_mov_b32 s7, 0x20000
  v_lshlrev_b32 v21, 7, v0
  v_readfirstlane_b32 s50, v1
  s_bfe_u32 s51, s2, 0x20003
  s_cmp_lg_u32 s50, s51
  s_cbranch_scc1 L_nopf
  buffer_load_dword v192, v21, s[4:7], 0 offen
L_nopf:
  v_and_b32 v0, 63, v0
  s_and_b32 s3, s2, 7

  v_readfirstlane_b32 s31, v1
  s_lshr_b32 s50, s2, 4
  s_lshl_b32 s50, s50, 3
  s_add_u32 s3, s3, s50
  s_bfe_u32 s50, s2, 0x10003
  s_lshl_b32 s51, s3, 1
  s_add_u32 s51, s51, s50
  s_mul_i32 s3, s3, 98304
  s_mul_i32 s51, s51, 98304
  v_and_b32 v220, 15, v0
  v_lshrrev_b32 v224, 4, v0
  v_lshlrev_b32 v221, 4, v224
  v_lshl_add_u32 v1, v220, 8, v221
  v_and_b32 v222, 3, v0
  v_bfe_u32 v223, v0, 2, 2
  v_lshlrev_b32 v225, 8, v223
  v_lshl_add_u32 v225, v224, 6, v225
  v_lshl_add_u32 v28, v222, 4, v225
  s_lshl_b32 s24, s31, 11
  s_lshl_b32 s28, s31, 13
  s_add_u32 s56, s28, 4096
  s_mov_b32 s10, 98304
  s_mov_b32 s11, 0x20000
  s_mov_b32 s14, 98304
  s_mov_b32 s15, 0x20000
  s_mov_b32 s18, 98304
  s_mov_b32 s19, 0x20000
  s_lshl_b32 s50, s31, 4
  s_and_b32 s50, s50, 32
  s_lshl_b32 s59, s31, 5
  s_and_b32 s59, s59, 0
  v_add_u32 v225, s24, v28
  v_xor_b32 v6, s50, v225
  v_xor_b32 v7, s59, v225
  s_add_u32 s29, s28, 32768
  s_add_u32 s57, s28, 36864
  s_mov_b32 s32, 0
  s_mov_b32 s33, 8192
  s_mov_b32 s34, 16384
  s_mov_b32 s35, 24576
  s_mov_b32 s36, 32768
  s_waitcnt lgkmcnt(0)
  s_add_u32 s8, s96, s51
  s_addc_u32 s9, s97, 0
  s_and_b32 s9, s9, 0xffff
  s_add_u32 s12, s98, s3
  s_addc_u32 s13, s99, 0
  s_and_b32 s13, s13, 0xffff
  s_add_u32 s16, s52, s3
  s_addc_u32 s17, s53, 0
  s_and_b32 s17, s17, 0xffff
  buffer_load_dwordx4 v[96:99], v28, s[8:11], s28 offen offset:0 nt
  buffer_load_dwordx4 v[100:103], v28, s[8:11], s28 offen offset:1024 nt
  s_barrier
  buffer_load_dwordx4 v[104:107], v28, s[8:11], s28 offen offset:2048 nt
  buffer_load_dwordx4 v[108:111], v28, s[8:11], s28 offen offset:3072 nt
  s_barrier
  buffer_load_dwordx4 v[112:115], v28, s[8:11], s56 offen offset:0 nt
  buffer_load_dwordx4 v[116:119], v28, s[8:11], s56 offen offset:1024 nt
  s_barrier
  buffer_load_dwordx4 v[120:123], v28, s[8:11], s56 offen offset:2048 nt
  buffer_load_dwordx4 v[124:127], v28, s[8:11], s56 offen offset:3072 nt
  s_barrier
  s_add_u32 m0, s24, 0
  s_nop 0
  buffer_load_dwordx4 v6, s[12:15], s32 offen offset:0 nt lds
  buffer_load_dwordx4 v6, s[12:15], s32 offen offset:1024 nt lds
  s_add_u32 m0, s24, 8192
  s_nop 0
  buffer_load_dwordx4 v6, s[12:15], s33 offen offset:0 nt lds
  buffer_load_dwordx4 v6, s[12:15], s33 offen offset:1024 nt lds
  s_add_u32 s20, s54, s51
  s_addc_u32 s21, s55, 0
  s_and_b32 s21, s21, 0xffff
  s_mov_b32 s22, 98304
  s_mov_b32 s23, 0x20000
  s_add_u32 s30, s28, 65536
  s_add_u32 s58, s28, 69632
  s_mov_b32 s25, 0x3e0293ee
  s_mov_b32 s62, 0x3e0293ee
  s_mov_b32 s63, 0x3e0293ee
  s_mov_b32 s26, 0xffff0000
  s_mov_b32 s27, 0x4e800000
  s_lshl_b32 s60, s31, 15
  s_and_b32 s60, s60, 0x10000
  s_bfe_u32 s50, s31, 0x10000
  s_lshl_b32 s50, s50, 12
  s_add_u32 s60, s60, s50
  s_add_u32 s60, s60, 90112
  s_mov_b32 s37, 40960
  s_mov_b32 s38, 49152
  s_mov_b32 s39, 57344
  s_mov_b32 s40, 65536
  s_mov_b32 s41, 73728
  s_mov_b32 s42, 81920
  s_mov_b32 s43, 90112
  v_and_b32 v160, 3, v0
  v_bfe_u32 v161, v0, 2, 2
  v_lshrrev_b32 v162, 4, v0
  v_and_b32 v163, 0xf0, v1
  v_and_b32 v164, 8, v0
  v_lshlrev_b32 v164, 2, v164
  v_xor_b32 v163, v163, v164
  v_lshl_add_u32 v163, v160, 6, v163
  v_lshl_add_u32 v2, v161, 11, v163
  s_lshl_b32 s50, s31, 12
  s_add_u32 s50, s50, 65536
  v_lshl_add_u32 v29, v161, 10, v163
  v_add_u32 v29, s50, v29
  v_lshlrev_b32 v163, 4, v0
  v_add_u32 v30, s50, v163
  v_xor_b32 v31, 32, v30
  v_add_u32 v3, 0x10000, v2
  v_lshlrev_b32 v163, 11, v162
  v_lshl_add_u32 v163, v161, 6, v163
  v_lshl_add_u32 v163, v160, 4, v163
  v_and_b32 v164, 0, v0
  v_lshl_add_u32 v163, v164, 1, v163
  v_add_u32 v4, 98304, v163
  v_xor_b32 v5, 32, v4
  v_lshrrev_b32 v163, 4, v0
  v_xor_b32 v163, v163, v0
  v_and_b32 v163, 2, v163
  v_mov_b32 v164, 0x3f803f80
  v_cmp_eq_u32 vcc, 0, v163
  v_bfe_i32 v165, v0, 0, 1
  v_and_b32 v165, 0xaaaaaaaa, v165
  v_mov_b32 v14, 0
  v_mov_b32 v15, 0
  v_mov_b32 v16, 0
  v_mov_b32 v17, 0
  v_mov_b32 v18, 0
  v_mov_b32 v19, 0
  v_mov_b32 v20, 0
  v_mov_b32 v21, 0
  v_mov_b32 v22, 0
  v_mov_b32 v23, 0
  v_mov_b32 v24, 0
  v_mov_b32 v25, 0
  v_mov_b32 v26, 0
  v_mov_b32 v27, 0
  v_cndmask_b32 v10, 0, v164, vcc
  v_cndmask_b32 v11, 0, v164, vcc
  v_cndmask_b32 v12, 0, v164, vcc
  v_cndmask_b32 v13, 0, v164, vcc
  v_or_b32 v0, 0x44444444, v165
  s_mov_b64 vcc, -1
  s_cmp_eq_u32 s31, 0
  s_cbranch_scc1 L_t0
  s_cmp_eq_u32 s31, 1
  s_cbranch_scc1 L_t1
  s_cmp_eq_u32 s31, 2
  s_cbranch_scc1 L_t2
  s_branch L_t3
L_back:
  s_mov_b64 vcc, 0
  s_waitcnt vmcnt(11)
  v_lshlrev_b32 v8, 16, v96
  v_and_b32 v9, s26, v96
  v_pk_mul_f32 v[8:9], v[8:9], s[62:63]
  v_cvt_pk_bf16_f32 v96, v8, v9
  v_lshlrev_b32 v8, 16, v97
  v_and_b32 v9, s26, v97
  v_pk_mul_f32 v[8:9], v[8:9], s[62:63]
  v_cvt_pk_bf16_f32 v97, v8, v9
  v_lshlrev_b32 v8, 16, v98
  v_and_b32 v9, s26, v98
  v_pk_mul_f32 v[8:9], v[8:9], s[62:63]
  v_cvt_pk_bf16_f32 v98, v8, v9
  v_lshlrev_b32 v8, 16, v99
  v_and_b32 v9, s26, v99
  v_pk_mul_f32 v[8:9], v[8:9], s[62:63]
  v_cvt_pk_bf16_f32 v99, v8, v9
  ds_write_b128 v30, v[96:99] offset:0
  s_waitcnt vmcnt(10)
  v_lshlrev_b32 v8, 16, v100
  v_and_b32 v9, s26, v100
  v_pk_mul_f32 v[8:9], v[8:9], s[62:63]
  v_cvt_pk_bf16_f32 v100, v8, v9
  v_lshlrev_b32 v8, 16, v101
  v_and_b32 v9, s26, v101
  v_pk_mul_f32 v[8:9], v[8:9], s[62:63]
  v_cvt_pk_bf16_f32 v101, v8, v9
  v_lshlrev_b32 v8, 16, v102
  v_and_b32 v9, s26, v102
  v_pk_mul_f32 v[8:9], v[8:9], s[62:63]
  v_cvt_pk_bf16_f32 v102, v8, v9
  v_lshlrev_b32 v8, 16, v103
  v_and_b32 v9, s26, v103
  v_pk_mul_f32 v[8:9], v[8:9], s[62:63]
  v_cvt_pk_bf16_f32 v103, v8, v9
  ds_write_b128 v30, v[100:103] offset:1024
  s_add_u32 m0, s24, 131072
  s_nop 0
  buffer_load_dwordx4 v7, s[16:19], s32 offen offset:0 nt lds
  buffer_load_dwordx4 v7, s[16:19], s32 offen offset:1024 nt lds
  s_waitcnt vmcnt(11)
  v_lshlrev_b32 v8, 16, v104
  v_and_b32 v9, s26, v104
  v_pk_mul_f32 v[8:9], v[8:9], s[62:63]
  v_cvt_pk_bf16_f32 v104, v8, v9
  v_lshlrev_b32 v8, 16, v105
  v_and_b32 v9, s26, v105
  v_pk_mul_f32 v[8:9], v[8:9], s[62:63]
  v_cvt_pk_bf16_f32 v105, v8, v9
  v_lshlrev_b32 v8, 16, v106
  v_and_b32 v9, s26, v106
  v_pk_mul_f32 v[8:9], v[8:9], s[62:63]
  v_cvt_pk_bf16_f32 v106, v8, v9
  v_lshlrev_b32 v8, 16, v107
  v_and_b32 v9, s26, v107
  v_pk_mul_f32 v[8:9], v[8:9], s[62:63]
  v_cvt_pk_bf16_f32 v107, v8, v9
  ds_write_b128 v31, v[104:107] offset:2048
  buffer_load_dwordx4 v[128:131], v28, s[8:11], s29 offen offset:0 nt
  s_waitcnt vmcnt(11)
  v_lshlrev_b32 v8, 16, v108
  v_and_b32 v9, s26, v108
  v_pk_mul_f32 v[8:9], v[8:9], s[62:63]
  v_cvt_pk_bf16_f32 v108, v8, v9
  v_lshlrev_b32 v8, 16, v109
  v_and_b32 v9, s26, v109
  v_pk_mul_f32 v[8:9], v[8:9], s[62:63]
  v_cvt_pk_bf16_f32 v109, v8, v9
  v_lshlrev_b32 v8, 16, v110
  v_and_b32 v9, s26, v110
  v_pk_mul_f32 v[8:9], v[8:9], s[62:63]
  v_cvt_pk_bf16_f32 v110, v8, v9
  v_lshlrev_b32 v8, 16, v111
  v_and_b32 v9, s26, v111
  v_pk_mul_f32 v[8:9], v[8:9], s[62:63]
  v_cvt_pk_bf16_f32 v111, v8, v9
  ds_write_b128 v31, v[108:111] offset:3072
  ds_read_b128 a[0:3], v29 offset:0
  ds_read_b128 a[4:7], v29 offset:256
  ds_read_b128 a[8:11], v29 offset:512
  ds_read_b128 a[12:15], v29 offset:768
  s_waitcnt vmcnt(10)
  v_lshlrev_b32 v8, 16, v112
  v_and_b32 v9, s26, v112
  v_pk_mul_f32 v[8:9], v[8:9], s[62:63]
  v_cvt_pk_bf16_f32 v112, v8, v9
  v_lshlrev_b32 v8, 16, v113
  v_and_b32 v9, s26, v113
  v_pk_mul_f32 v[8:9], v[8:9], s[62:63]
  v_cvt_pk_bf16_f32 v113, v8, v9
  v_lshlrev_b32 v8, 16, v114
  v_and_b32 v9, s26, v114
  v_pk_mul_f32 v[8:9], v[8:9], s[62:63]
  v_cvt_pk_bf16_f32 v114, v8, v9
  v_lshlrev_b32 v8, 16, v115
  v_and_b32 v9, s26, v115
  v_pk_mul_f32 v[8:9], v[8:9], s[62:63]
  v_cvt_pk_bf16_f32 v115, v8, v9
  ds_write_b128 v30, v[112:115] offset:16384
  s_add_u32 m0, s24, 16384
  s_nop 0
  buffer_load_dwordx4 v6, s[12:15], s34 offen offset:0 nt lds
  buffer_load_dwordx4 v6, s[12:15], s34 offen offset:1024 nt lds
  s_waitcnt vmcnt(11)
  buffer_load_dwordx4 v[132:135], v28, s[8:11], s29 offen offset:1024 nt
  v_lshlrev_b32 v8, 16, v116
  v_and_b32 v9, s26, v116
  v_pk_mul_f32 v[8:9], v[8:9], s[62:63]
  v_cvt_pk_bf16_f32 v116, v8, v9
  v_lshlrev_b32 v8, 16, v117
  v_and_b32 v9, s26, v117
  v_pk_mul_f32 v[8:9], v[8:9], s[62:63]
  v_cvt_pk_bf16_f32 v117, v8, v9
  v_lshlrev_b32 v8, 16, v118
  v_and_b32 v9, s26, v118
  v_pk_mul_f32 v[8:9], v[8:9], s[62:63]
  v_cvt_pk_bf16_f32 v118, v8, v9
  v_lshlrev_b32 v8, 16, v119
  v_and_b32 v9, s26, v119
  v_pk_mul_f32 v[8:9], v[8:9], s[62:63]
  v_cvt_pk_bf16_f32 v119, v8, v9
  ds_write_b128 v30, v[116:119] offset:17408
  s_waitcnt vmcnt(11)
  v_lshlrev_b32 v8, 16, v120
  v_and_b32 v9, s26, v120
  v_pk_mul_f32 v[8:9], v[8:9], s[62:63]
  v_cvt_pk_bf16_f32 v120, v8, v9
  v_lshlrev_b32 v8, 16, v121
  v_and_b32 v9, s26, v121
  v_pk_mul_f32 v[8:9], v[8:9], s[62:63]
  v_cvt_pk_bf16_f32 v121, v8, v9
  v_lshlrev_b32 v8, 16, v122
  v_and_b32 v9, s26, v122
  v_pk_mul_f32 v[8:9], v[8:9], s[62:63]
  v_cvt_pk_bf16_f32 v122, v8, v9
  v_lshlrev_b32 v8, 16, v123
  v_and_b32 v9, s26, v123
  v_pk_mul_f32 v[8:9], v[8:9], s[62:63]
  v_cvt_pk_bf16_f32 v123, v8, v9
  ds_write_b128 v31, v[120:123] offset:18432
  buffer_load_dwordx4 v[144:147], v28, s[8:11], s29 offen offset:2048 nt
  s_waitcnt vmcnt(11)
  v_lshlrev_b32 v8, 16, v124
  v_and_b32 v9, s26, v124
  v_pk_mul_f32 v[8:9], v[8:9], s[62:63]
  v_cvt_pk_bf16_f32 v124, v8, v9
  v_lshlrev_b32 v8, 16, v125
  v_and_b32 v9, s26, v125
  v_pk_mul_f32 v[8:9], v[8:9], s[62:63]
  v_cvt_pk_bf16_f32 v125, v8, v9
  v_lshlrev_b32 v8, 16, v126
  v_and_b32 v9, s26, v126
  v_pk_mul_f32 v[8:9], v[8:9], s[62:63]
  v_cvt_pk_bf16_f32 v126, v8, v9
  v_lshlrev_b32 v8, 16, v127
  v_and_b32 v9, s26, v127
  v_pk_mul_f32 v[8:9], v[8:9], s[62:63]
  v_cvt_pk_bf16_f32 v127, v8, v9
  ds_write_b128 v31, v[124:127] offset:19456
  s_branch L_main
.p2alignl 12, 0xbf810000
L_main:
L_t0:
  s_cbranch_vccnz L_t4
  ds_read_b128 a[16:19], v29 offset:16384
  ds_read_b128 a[20:23], v29 offset:16640
  ds_read_b128 a[24:27], v29 offset:16896
  ds_read_b128 a[28:31], v29 offset:17152
  s_waitcnt vmcnt(9)
  s_barrier
  ds_read_b128 a[64:67], v2 offset:0
  ds_read_b128 a[72:75], v2 offset:256
  ds_read_b128 a[80:83], v2 offset:512
  ds_read_b128 a[88:91], v2 offset:768
  ds_read_b128 a[92:95], v2 offset:1792
  ds_read_b128 a[84:87], v2 offset:1536
  ds_read_b128 a[76:79], v2 offset:1280
  ds_read_b128 a[68:71], v2 offset:1024
  s_waitcnt lgkmcnt(7)
  v_mfma_f32_16x16x32_bf16 v[160:163], a[64:67], a[0:3], 0
  s_waitcnt lgkmcnt(6)
  s_add_u32 m0, s24, 139264
  v_mfma_f32_16x16x32_bf16 v[160:163], a[72:75], a[4:7], v[160:163]
  s_waitcnt lgkmcnt(5)
  buffer_load_dwordx4 v7, s[16:19], s33 offen offset:0 nt lds
  v_mfma_f32_16x16x32_bf16 v[160:163], a[80:83], a[8:11], v[160:163]
  s_waitcnt lgkmcnt(4)
  v_mfma_f32_16x16x32_bf16 v[160:163], a[88:91], a[12:15], v[160:163]
  s_waitcnt lgkmcnt(3)
  buffer_load_dwordx4 v7, s[16:19], s33 offen offset:1024 nt lds
  v_mfma_f32_16x16x32_bf16 v[164:167], a[92:95], a[12:15], 0
  s_waitcnt lgkmcnt(2)
  v_mfma_f32_16x16x32_bf16 v[164:167], a[84:87], a[8:11], v[164:167]
  s_waitcnt lgkmcnt(1)
  buffer_load_dwordx4 v[148:151], v28, s[8:11], s29 offen offset:3072 nt
  v_mfma_f32_16x16x32_bf16 v[164:167], a[76:79], a[4:7], v[164:167]
  s_waitcnt lgkmcnt(0)
  v_mfma_f32_16x16x32_bf16 v[164:167], a[68:71], a[0:3], v[164:167]
  v_mfma_f32_16x16x32_bf16 v[172:175], a[68:71], a[16:19], 0
  v_mfma_f32_16x16x32_bf16 v[172:175], a[76:79], a[20:23], v[172:175]
  v_mfma_f32_16x16x32_bf16 v[172:175], a[84:87], a[24:27], v[172:175]
  v_max3_f32 v240, v160, v161, v162
  v_max3_f32 v240, v240, v163, v164
  v_mfma_f32_16x16x32_bf16 v[172:175], a[92:95], a[28:31], v[172:175]
  v_max3_f32 v240, v240, v165, v166
  v_max_f32 v240, v240, v167
  v_mfma_f32_16x16x32_bf16 v[168:171], a[88:91], a[28:31], 0
  v_mov_b32 v5, v240
  v_mfma_f32_16x16x32_bf16 v[168:171], a[80:83], a[24:27], v[168:171]
  s_nop 0
  v_permlane32_swap_b32 v240, v5
  v_max_f32 v240, v240, v5
  v_mov_b32 v5, v240
  v_mfma_f32_16x16x32_bf16 v[168:171], a[72:75], a[20:23], v[168:171]
  s_waitcnt vmcnt(10)
  s_barrier
  v_permlane16_swap_b32 v240, v5
  v_min_f32 v240, -v240, -v5
  v_add_f32 v240, 0xc1400000, v240
  v_mov_b32 v241, v240
  v_mov_b32 v242, v240
  v_mov_b32 v243, v240
  v_mfma_f32_16x16x32_bf16 v[168:171], a[64:67], a[16:19], v[168:171]
  ds_read_b128 a[96:99], v2 offset:8192
  ds_read_b128 a[100:103], v2 offset:9216
  ds_read_b128 a[104:107], v2 offset:8448
  ds_read_b128 a[108:111], v2 offset:9472
  ds_read_b128 a[112:115], v2 offset:8704
  ds_read_b128 a[116:119], v2 offset:9728
  ds_read_b128 a[120:123], v2 offset:8960
  ds_read_b128 a[124:127], v2 offset:9984
  s_waitcnt lgkmcnt(7)
  v_mfma_f32_16x16x32_bf16 v[176:179], a[96:99], a[0:3], v[240:243]
  s_waitcnt lgkmcnt(5)
  v_add_f32 v160, v240, v160
  v_add_f32 v161, v240, v161
  v_mfma_f32_16x16x32_bf16 v[176:179], a[104:107], a[4:7], v[176:179]
  s_waitcnt lgkmcnt(3)
  buffer_load_dwordx4 v[136:139], v28, s[8:11], s57 offen offset:0 nt
  v_add_f32 v162, v240, v162
  v_mfma_f32_16x16x32_bf16 v[176:179], a[112:115], a[8:11], v[176:179]
  s_waitcnt lgkmcnt(1)
  v_exp_f32 v160, v160
  v_mfma_f32_16x16x32_bf16 v[176:179], a[120:123], a[12:15], v[176:179]
  s_waitcnt lgkmcnt(0)
  v_exp_f32 v161, v161
  v_mfma_f32_16x16x32_bf16 v[180:183], a[124:127], a[12:15], v[240:243]
  v_exp_f32 v162, v162
  v_mfma_f32_16x16x32_bf16 v[180:183], a[116:119], a[8:11], v[180:183]
  v_add_f32 v163, v240, v163
  v_add_f32 v164, v240, v164
  v_mfma_f32_16x16x32_bf16 v[180:183], a[108:111], a[4:7], v[180:183]
  v_exp_f32 v163, v163
  v_mfma_f32_16x16x32_bf16 v[180:183], a[100:103], a[0:3], v[180:183]
  v_exp_f32 v164, v164
  v_mfma_f32_16x16x32_bf16 v[188:191], a[100:103], a[16:19], v[240:243]
  s_waitcnt vmcnt(9)
  s_barrier
  v_add_f32 v165, v240, v165
  v_mfma_f32_16x16x32_bf16 v[188:191], a[108:111], a[20:23], v[188:191]
  ds_read_b64_tr_b16 a[128:129], v4 offset:32768
  ds_read_b64_tr_b16 a[130:131], v4 offset:33792
  ds_read_b64_tr_b16 a[132:133], v4 offset:32776
  ds_read_b64_tr_b16 a[134:135], v4 offset:33800
  v_mfma_f32_16x16x32_bf16 v[188:191], a[116:119], a[24:27], v[188:191]
  s_add_u32 m0, s24, 24576
  ds_read_b64_tr_b16 a[136:137], v4 offset:33024
  ds_read_b64_tr_b16 a[138:139], v4 offset:34048
  v_mfma_f32_16x16x32_bf16 v[188:191], a[124:127], a[28:31], v[188:191]
  buffer_load_dwordx4 v6, s[12:15], s35 offen offset:0 nt lds
  ds_read_b64_tr_b16 a[140:141], v4 offset:33032
  v_mfma_f32_16x16x32_bf16 v[184:187], a[120:123], a[28:31], v[240:243]
  v_exp_f32 v165, v165
  v_mfma_f32_16x16x32_bf16 v[184:187], a[112:115], a[24:27], v[184:187]
  buffer_load_dwordx4 v6, s[12:15], s35 offen offset:1024 nt lds
  ds_read_b64_tr_b16 a[142:143], v4 offset:34056
  v_add_f32 v166, v240, v166
  v_exp_f32 v166, v166
  v_add_f32 v167, v240, v167
  v_exp_f32 v167, v167
  v_mfma_f32_16x16x32_bf16 v[184:187], a[104:107], a[20:23], v[184:187]
  v_cvt_pk_bf16_f32 v192, v160, v161
  v_cvt_pk_bf16_f32 v193, v162, v163
  v_cvt_pk_bf16_f32 v194, v164, v165
  v_cvt_pk_bf16_f32 v195, v166, v167
  v_add_f32 v168, v240, v168
  v_exp_f32 v168, v168
  v_add_f32 v169, v240, v169
  v_exp_f32 v169, v169
  v_add_f32 v170, v240, v170
  v_exp_f32 v170, v170
  v_add_f32 v171, v240, v171
  v_exp_f32 v171, v171
  v_add_f32 v172, v240, v172
  v_exp_f32 v172, v172
  v_add_f32 v173, v240, v173
  v_exp_f32 v173, v173
  v_add_f32 v174, v240, v174
  v_exp_f32 v174, v174
  v_add_f32 v175, v240, v175
  v_exp_f32 v175, v175
  v_mfma_f32_16x16x32_bf16 v[184:187], a[96:99], a[16:19], v[184:187]
  s_waitcnt lgkmcnt(4)
  buffer_load_dwordx4 v[140:143], v28, s[8:11], s57 offen offset:1024 nt
  ds_read_b64_tr_b16 a[144:145], v4 offset:33280
  ds_read_b64_tr_b16 a[146:147], v4 offset:34304
  v_cvt_pk_bf16_f32 v196, v168, v169
  v_cvt_pk_bf16_f32 v197, v170, v171
  v_cvt_pk_bf16_f32 v198, v172, v173
  v_cvt_pk_bf16_f32 v199, v174, v175
  v_mfma_f32_16x16x32_bf16 v[32:35], a[128:131], v[192:195], 0
  ds_read_b64_tr_b16 a[148:149], v4 offset:33288
  ds_read_b64_tr_b16 a[150:151], v4 offset:34312
  v_mfma_f32_16x16x32_bf16 v[40:43], a[128:131], v[196:199], 0
  ds_read_b64_tr_b16 a[152:153], v4 offset:33536
  ds_read_b64_tr_b16 a[154:155], v4 offset:34560
  v_mfma_f32_16x16x32_bf16 v[36:39], a[132:135], v[192:195], 0
  ds_read_b64_tr_b16 a[156:157], v4 offset:33544
  ds_read_b64_tr_b16 a[158:159], v4 offset:34568
  v_mfma_f32_16x16x32_bf16 v[44:47], a[132:135], v[196:199], 0
  v_exp_f32 v176, v176
  v_smfmac_f32_16x16x64_bf16 v[14:17], v[10:13], v[192:199], v0
  s_waitcnt lgkmcnt(8)
  v_mfma_f32_16x16x32_bf16 v[48:51], a[136:139], v[192:195], 0
  v_exp_f32 v177, v177
  v_mfma_f32_16x16x32_bf16 v[56:59], a[136:139], v[196:199], 0
  v_exp_f32 v178, v178
  v_mfma_f32_16x16x32_bf16 v[52:55], a[140:143], v[192:195], 0
  v_exp_f32 v179, v179
  v_mfma_f32_16x16x32_bf16 v[60:63], a[140:143], v[196:199], 0
  s_waitcnt lgkmcnt(0)
  v_exp_f32 v180, v180
  v_mfma_f32_16x16x32_bf16 v[64:67], a[144:147], v[192:195], 0
  s_waitcnt vmcnt(9)
  s_barrier
  v_cvt_pk_bf16_f32 v200, v176, v177
  v_mfma_f32_16x16x32_bf16 v[72:75], a[144:147], v[196:199], 0
  ds_read_b128 a[64:67], v2 offset:16384
  ds_read_b128 a[72:75], v2 offset:16640
  ds_read_b128 a[80:83], v2 offset:16896
  ds_read_b128 a[88:91], v2 offset:17152
  v_mfma_f32_16x16x32_bf16 v[68:71], a[148:151], v[192:195], 0
  ds_read_b128 a[92:95], v2 offset:18176
  ds_read_b128 a[84:87], v2 offset:17920
  v_mfma_f32_16x16x32_bf16 v[76:79], a[148:151], v[196:199], 0
  buffer_load_dwordx4 v[152:155], v28, s[8:11], s57 offen offset:2048 nt
  ds_read_b128 a[76:79], v2 offset:17664
  v_mfma_f32_16x16x32_bf16 v[80:83], a[152:155], v[192:195], 0
  s_add_u32 m0, s24, 147456
  ds_read_b128 a[68:71], v2 offset:17408
  v_lshlrev_b32 v8, 16, v128
  v_mfma_f32_16x16x32_bf16 v[88:91], a[152:155], v[196:199], 0
  buffer_load_dwordx4 v7, s[16:19], s34 offen offset:0 nt lds
  v_and_b32 v9, s26, v128
  v_mfma_f32_16x16x32_bf16 v[84:87], a[156:159], v[192:195], 0
  v_mul_f32 v8, s25, v8
  v_mul_f32 v9, s25, v9
  v_mfma_f32_16x16x32_bf16 v[92:95], a[156:159], v[196:199], 0
  s_waitcnt lgkmcnt(4)
  buffer_load_dwordx4 v7, s[16:19], s34 offen offset:1024 nt lds
  v_cvt_pk_bf16_f32 v128, v8, v9
  v_mfma_f32_16x16x32_bf16 v[160:163], a[64:67], a[0:3], v[240:243]
  v_lshlrev_b32 v8, 16, v129
  v_and_b32 v9, s26, v129
  v_mfma_f32_16x16x32_bf16 v[160:163], a[72:75], a[4:7], v[160:163]
  v_mul_f32 v8, s25, v8
  v_mul_f32 v9, s25, v9
  v_mfma_f32_16x16x32_bf16 v[160:163], a[80:83], a[8:11], v[160:163]
  v_cvt_pk_bf16_f32 v129, v8, v9
  v_lshlrev_b32 v8, 16, v130
  v_mfma_f32_16x16x32_bf16 v[160:163], a[88:91], a[12:15], v[160:163]
  s_waitcnt lgkmcnt(0)
  v_and_b32 v9, s26, v130
  v_mul_f32 v8, s25, v8
  v_mfma_f32_16x16x32_bf16 v[164:167], a[92:95], a[12:15], v[240:243]
  v_mul_f32 v9, s25, v9
  v_cvt_pk_bf16_f32 v130, v8, v9
  v_mfma_f32_16x16x32_bf16 v[164:167], a[84:87], a[8:11], v[164:167]
  v_lshlrev_b32 v8, 16, v131
  v_and_b32 v9, s26, v131
  v_mfma_f32_16x16x32_bf16 v[164:167], a[76:79], a[4:7], v[164:167]
  v_mul_f32 v8, s25, v8
  v_mul_f32 v9, s25, v9
  v_cvt_pk_bf16_f32 v131, v8, v9
  v_mfma_f32_16x16x32_bf16 v[164:167], a[68:71], a[0:3], v[164:167]
  ds_write_b128 v30, v[128:131] offset:0
  v_mfma_f32_16x16x32_bf16 v[172:175], a[68:71], a[16:19], v[240:243]
  s_waitcnt vmcnt(8)
  s_barrier
  v_cvt_pk_bf16_f32 v201, v178, v179
  v_mfma_f32_16x16x32_bf16 v[172:175], a[76:79], a[20:23], v[172:175]
  ds_read_b64_tr_b16 a[160:161], v4 offset:40960
  ds_read_b64_tr_b16 a[162:163], v4 offset:41984
  ds_read_b64_tr_b16 a[164:165], v4 offset:40968
  ds_read_b64_tr_b16 a[166:167], v4 offset:41992
  v_mfma_f32_16x16x32_bf16 v[172:175], a[84:87], a[24:27], v[172:175]
  ds_read_b64_tr_b16 a[168:169], v4 offset:41216
  ds_read_b64_tr_b16 a[170:171], v4 offset:42240
  v_mfma_f32_16x16x32_bf16 v[172:175], a[92:95], a[28:31], v[172:175]
  buffer_load_dwordx4 v[156:159], v28, s[8:11], s57 offen offset:3072 nt
  ds_read_b64_tr_b16 a[172:173], v4 offset:41224
  v_mfma_f32_16x16x32_bf16 v[168:171], a[88:91], a[28:31], v[240:243]
  s_add_u32 m0, s24, 155648
  v_exp_f32 v181, v181
  v_mfma_f32_16x16x32_bf16 v[168:171], a[80:83], a[24:27], v[168:171]
  buffer_load_dwordx4 v7, s[16:19], s35 offen offset:0 nt lds
  ds_read_b64_tr_b16 a[174:175], v4 offset:42248
  v_exp_f32 v182, v182
  v_exp_f32 v183, v183
  v_mfma_f32_16x16x32_bf16 v[168:171], a[72:75], a[20:23], v[168:171]
  v_cvt_pk_bf16_f32 v202, v180, v181
  v_cvt_pk_bf16_f32 v203, v182, v183
  v_exp_f32 v184, v184
  v_exp_f32 v185, v185
  v_exp_f32 v186, v186
  v_exp_f32 v187, v187
  v_exp_f32 v188, v188
  v_exp_f32 v189, v189
  v_exp_f32 v190, v190
  v_exp_f32 v191, v191
  v_mfma_f32_16x16x32_bf16 v[168:171], a[64:67], a[16:19], v[168:171]
  s_waitcnt lgkmcnt(4)
  buffer_load_dwordx4 v7, s[16:19], s35 offen offset:1024 nt lds
  ds_read_b64_tr_b16 a[176:177], v4 offset:41472
  ds_read_b64_tr_b16 a[178:179], v4 offset:42496
  v_cvt_pk_bf16_f32 v204, v184, v185
  v_cvt_pk_bf16_f32 v205, v186, v187
  v_cvt_pk_bf16_f32 v206, v188, v189
  v_cvt_pk_bf16_f32 v207, v190, v191
  v_mfma_f32_16x16x32_bf16 v[32:35], a[160:163], v[200:203], v[32:35]
  ds_read_b64_tr_b16 a[180:181], v4 offset:41480
  ds_read_b64_tr_b16 a[182:183], v4 offset:42504
  v_mfma_f32_16x16x32_bf16 v[40:43], a[160:163], v[204:207], v[40:43]
  ds_read_b64_tr_b16 a[184:185], v4 offset:41728
  ds_read_b64_tr_b16 a[186:187], v4 offset:42752
  v_mfma_f32_16x16x32_bf16 v[36:39], a[164:167], v[200:203], v[36:39]
  ds_read_b64_tr_b16 a[188:189], v4 offset:41736
  ds_read_b64_tr_b16 a[190:191], v4 offset:42760
  v_mfma_f32_16x16x32_bf16 v[44:47], a[164:167], v[204:207], v[44:47]
  v_lshlrev_b32 v8, 16, v132
  v_and_b32 v9, s26, v132
  v_smfmac_f32_16x16x64_bf16 v[14:17], v[10:13], v[200:207], v0
  s_waitcnt lgkmcnt(8)
  v_mul_f32 v8, s25, v8
  v_mfma_f32_16x16x32_bf16 v[48:51], a[168:171], v[200:203], v[48:51]
  v_mul_f32 v9, s25, v9
  v_cvt_pk_bf16_f32 v132, v8, v9
  v_mfma_f32_16x16x32_bf16 v[56:59], a[168:171], v[204:207], v[56:59]
  v_lshlrev_b32 v8, 16, v133
  v_and_b32 v9, s26, v133
  v_mul_f32 v8, s25, v8
  v_mul_f32 v9, s25, v9
  v_cvt_pk_bf16_f32 v133, v8, v9
  v_lshlrev_b32 v8, 16, v134
  v_and_b32 v9, s26, v134
  v_pk_mul_f32 v[8:9], v[8:9], s[62:63]
  v_cvt_pk_bf16_f32 v134, v8, v9
  v_lshlrev_b32 v8, 16, v135
  v_and_b32 v9, s26, v135
  v_pk_mul_f32 v[8:9], v[8:9], s[62:63]
  v_cvt_pk_bf16_f32 v135, v8, v9
  v_mfma_f32_16x16x32_bf16 v[52:55], a[172:175], v[200:203], v[52:55]
  ds_write_b128 v30, v[132:135] offset:1024
  v_lshlrev_b32 v8, 16, v144
  v_and_b32 v9, s26, v144
  v_pk_mul_f32 v[8:9], v[8:9], s[62:63]
  v_cvt_pk_bf16_f32 v144, v8, v9
  v_lshlrev_b32 v8, 16, v145
  v_and_b32 v9, s26, v145
  v_pk_mul_f32 v[8:9], v[8:9], s[62:63]
  v_cvt_pk_bf16_f32 v145, v8, v9
  v_lshlrev_b32 v8, 16, v146
  v_and_b32 v9, s26, v146
  v_pk_mul_f32 v[8:9], v[8:9], s[62:63]
  v_cvt_pk_bf16_f32 v146, v8, v9
  v_lshlrev_b32 v8, 16, v147
  v_and_b32 v9, s26, v147
  v_pk_mul_f32 v[8:9], v[8:9], s[62:63]
  v_cvt_pk_bf16_f32 v147, v8, v9
  v_mfma_f32_16x16x32_bf16 v[60:63], a[172:175], v[204:207], v[60:63]
  s_waitcnt lgkmcnt(1)
  ds_write_b128 v31, v[144:147] offset:2048
  v_mfma_f32_16x16x32_bf16 v[64:67], a[176:179], v[200:203], v[64:67]
  s_waitcnt vmcnt(7)
  s_barrier
  v_mfma_f32_16x16x32_bf16 v[72:75], a[176:179], v[204:207], v[72:75]
  ds_read_b128 a[64:67], v2 offset:24576
  ds_read_b128 a[72:75], v2 offset:24832
  ds_read_b128 a[80:83], v2 offset:25088
  ds_read_b128 a[88:91], v2 offset:25344
  v_mfma_f32_16x16x32_bf16 v[68:71], a[180:183], v[200:203], v[68:71]
  ds_read_b128 a[92:95], v2 offset:26368
  ds_read_b128 a[84:87], v2 offset:26112
  v_mfma_f32_16x16x32_bf16 v[76:79], a[180:183], v[204:207], v[76:79]
  ds_read_b128 a[76:79], v2 offset:25856
  ds_read_b128 a[68:71], v2 offset:25600
  v_mfma_f32_16x16x32_bf16 v[80:83], a[184:187], v[200:203], v[80:83]
  v_lshlrev_b32 v8, 16, v148
  v_and_b32 v9, s26, v148
  v_mfma_f32_16x16x32_bf16 v[88:91], a[184:187], v[204:207], v[88:91]
  v_mul_f32 v8, s25, v8
  v_mul_f32 v9, s25, v9
  v_mfma_f32_16x16x32_bf16 v[84:87], a[188:191], v[200:203], v[84:87]
  v_cvt_pk_bf16_f32 v148, v8, v9
  v_lshlrev_b32 v8, 16, v149
  v_mfma_f32_16x16x32_bf16 v[92:95], a[188:191], v[204:207], v[92:95]
  s_waitcnt lgkmcnt(4)
  v_and_b32 v9, s26, v149
  v_mul_f32 v8, s25, v8
  v_mfma_f32_16x16x32_bf16 v[176:179], a[64:67], a[0:3], v[240:243]
  v_mul_f32 v9, s25, v9
  v_cvt_pk_bf16_f32 v149, v8, v9
  v_mfma_f32_16x16x32_bf16 v[176:179], a[72:75], a[4:7], v[176:179]
  v_lshlrev_b32 v8, 16, v150
  v_and_b32 v9, s26, v150
  v_mfma_f32_16x16x32_bf16 v[176:179], a[80:83], a[8:11], v[176:179]
  v_mul_f32 v8, s25, v8
  v_mul_f32 v9, s25, v9
  v_mfma_f32_16x16x32_bf16 v[176:179], a[88:91], a[12:15], v[176:179]
  s_waitcnt lgkmcnt(0)
  v_cvt_pk_bf16_f32 v150, v8, v9
  v_lshlrev_b32 v8, 16, v151
  v_mfma_f32_16x16x32_bf16 v[180:183], a[92:95], a[12:15], v[240:243]
  v_and_b32 v9, s26, v151
  v_mul_f32 v8, s25, v8
  v_mfma_f32_16x16x32_bf16 v[180:183], a[84:87], a[8:11], v[180:183]
  v_mul_f32 v9, s25, v9
  v_cvt_pk_bf16_f32 v151, v8, v9
  v_mfma_f32_16x16x32_bf16 v[180:183], a[76:79], a[4:7], v[180:183]
  ds_write_b128 v31, v[148:151] offset:3072
  v_lshlrev_b32 v8, 16, v136
  v_and_b32 v9, s26, v136
  v_pk_mul_f32 v[8:9], v[8:9], s[62:63]
  v_cvt_pk_bf16_f32 v136, v8, v9
  v_lshlrev_b32 v8, 16, v137
  v_and_b32 v9, s26, v137
  v_pk_mul_f32 v[8:9], v[8:9], s[62:63]
  v_cvt_pk_bf16_f32 v137, v8, v9
  v_lshlrev_b32 v8, 16, v138
  v_and_b32 v9, s26, v138
  v_pk_mul_f32 v[8:9], v[8:9], s[62:63]
  v_cvt_pk_bf16_f32 v138, v8, v9
  v_lshlrev_b32 v8, 16, v139
  v_and_b32 v9, s26, v139
  v_pk_mul_f32 v[8:9], v[8:9], s[62:63]
  v_cvt_pk_bf16_f32 v139, v8, v9
  v_mfma_f32_16x16x32_bf16 v[180:183], a[68:71], a[0:3], v[180:183]
  ds_write_b128 v30, v[136:139] offset:16384
  v_mfma_f32_16x16x32_bf16 v[188:191], a[68:71], a[16:19], v[240:243]
  s_waitcnt vmcnt(3)
  s_barrier
  ds_read_b128 a[32:35], v29 offset:0
  v_mfma_f32_16x16x32_bf16 v[188:191], a[76:79], a[20:23], v[188:191]
  ds_read_b64_tr_b16 a[192:193], v4 offset:49152
  ds_read_b64_tr_b16 a[194:195], v4 offset:50176
  ds_read_b64_tr_b16 a[196:197], v4 offset:49160
  ds_read_b64_tr_b16 a[198:199], v4 offset:50184
  v_mfma_f32_16x16x32_bf16 v[188:191], a[84:87], a[24:27], v[188:191]
  ds_read_b64_tr_b16 a[200:201], v4 offset:49408
  ds_read_b64_tr_b16 a[202:203], v4 offset:50432
  v_mfma_f32_16x16x32_bf16 v[188:191], a[92:95], a[28:31], v[188:191]
  v_exp_f32 v160, v160
  v_mfma_f32_16x16x32_bf16 v[184:187], a[88:91], a[28:31], v[240:243]
  v_exp_f32 v161, v161
  v_mfma_f32_16x16x32_bf16 v[184:187], a[80:83], a[24:27], v[184:187]
  ds_read_b64_tr_b16 a[204:205], v4 offset:49416
  ds_read_b64_tr_b16 a[206:207], v4 offset:50440
  v_exp_f32 v162, v162
  v_exp_f32 v163, v163
  v_exp_f32 v164, v164
  v_exp_f32 v165, v165
  v_exp_f32 v166, v166
  v_exp_f32 v167, v167
  v_mfma_f32_16x16x32_bf16 v[184:187], a[72:75], a[20:23], v[184:187]
  v_cvt_pk_bf16_f32 v192, v160, v161
  v_cvt_pk_bf16_f32 v193, v162, v163
  v_cvt_pk_bf16_f32 v194, v164, v165
  v_cvt_pk_bf16_f32 v195, v166, v167
  v_exp_f32 v168, v168
  v_exp_f32 v169, v169
  v_exp_f32 v170, v170
  v_exp_f32 v171, v171
  v_exp_f32 v172, v172
  v_exp_f32 v173, v173
  v_exp_f32 v174, v174
  v_exp_f32 v175, v175
  v_mfma_f32_16x16x32_bf16 v[184:187], a[64:67], a[16:19], v[184:187]
  s_waitcnt lgkmcnt(4)
  ds_read_b64_tr_b16 a[208:209], v4 offset:49664
  ds_read_b64_tr_b16 a[210:211], v4 offset:50688
  v_cvt_pk_bf16_f32 v196, v168, v169
  v_cvt_pk_bf16_f32 v197, v170, v171
  v_cvt_pk_bf16_f32 v198, v172, v173
  v_cvt_pk_bf16_f32 v199, v174, v175
  v_mfma_f32_16x16x32_bf16 v[32:35], a[192:195], v[192:195], v[32:35]
  ds_read_b64_tr_b16 a[212:213], v4 offset:49672
  ds_read_b64_tr_b16 a[214:215], v4 offset:50696
  v_mfma_f32_16x16x32_bf16 v[40:43], a[192:195], v[196:199], v[40:43]
  ds_read_b64_tr_b16 a[216:217], v4 offset:49920
  ds_read_b64_tr_b16 a[218:219], v4 offset:50944
  v_mfma_f32_16x16x32_bf16 v[36:39], a[196:199], v[192:195], v[36:39]
  s_add_u32 m0, s24, 32768
  ds_read_b64_tr_b16 a[220:221], v4 offset:49928
  ds_read_b64_tr_b16 a[222:223], v4 offset:50952
  v_mfma_f32_16x16x32_bf16 v[44:47], a[196:199], v[196:199], v[44:47]
  buffer_load_dwordx4 v6, s[12:15], s36 offen offset:0 nt lds
  ds_read_b128 a[36:39], v29 offset:256
  v_smfmac_f32_16x16x64_bf16 v[14:17], v[10:13], v[192:199], v0
  s_waitcnt lgkmcnt(9)
  ds_read_b128 a[40:43], v29 offset:512
  v_mfma_f32_16x16x32_bf16 v[48:51], a[200:203], v[192:195], v[48:51]
  ds_read_b128 a[44:47], v29 offset:768
  v_lshlrev_b32 v8, 16, v140
  v_mfma_f32_16x16x32_bf16 v[56:59], a[200:203], v[196:199], v[56:59]
  buffer_load_dwordx4 v6, s[12:15], s36 offen offset:1024 nt lds
  v_and_b32 v9, s26, v140
  v_mfma_f32_16x16x32_bf16 v[52:55], a[204:207], v[192:195], v[52:55]
  v_mul_f32 v8, s25, v8
  v_mul_f32 v9, s25, v9
  v_mfma_f32_16x16x32_bf16 v[60:63], a[204:207], v[196:199], v[60:63]
  s_waitcnt lgkmcnt(3)
  v_cvt_pk_bf16_f32 v140, v8, v9
  v_lshlrev_b32 v8, 16, v141
  v_mfma_f32_16x16x32_bf16 v[64:67], a[208:211], v[192:195], v[64:67]
  v_and_b32 v9, s26, v141
  v_mul_f32 v8, s25, v8
  v_mfma_f32_16x16x32_bf16 v[72:75], a[208:211], v[196:199], v[72:75]
  v_mul_f32 v9, s25, v9
  v_cvt_pk_bf16_f32 v141, v8, v9
  v_mfma_f32_16x16x32_bf16 v[68:71], a[212:215], v[192:195], v[68:71]
  v_lshlrev_b32 v8, 16, v142
  v_and_b32 v9, s26, v142
  v_mfma_f32_16x16x32_bf16 v[76:79], a[212:215], v[196:199], v[76:79]
  v_mul_f32 v8, s25, v8
  v_mul_f32 v9, s25, v9
  v_mfma_f32_16x16x32_bf16 v[80:83], a[216:219], v[192:195], v[80:83]
  v_cvt_pk_bf16_f32 v142, v8, v9
  v_lshlrev_b32 v8, 16, v143
  v_mfma_f32_16x16x32_bf16 v[88:91], a[216:219], v[196:199], v[88:91]
  v_and_b32 v9, s26, v143
  v_mul_f32 v8, s25, v8
  v_mul_f32 v9, s25, v9
  v_cvt_pk_bf16_f32 v143, v8, v9
  v_mfma_f32_16x16x32_bf16 v[84:87], a[220:223], v[192:195], v[84:87]
  ds_write_b128 v30, v[140:143] offset:17408
  v_lshlrev_b32 v8, 16, v152
  v_and_b32 v9, s26, v152
  v_pk_mul_f32 v[8:9], v[8:9], s[62:63]
  v_cvt_pk_bf16_f32 v152, v8, v9
  v_lshlrev_b32 v8, 16, v153
  v_and_b32 v9, s26, v153
  v_pk_mul_f32 v[8:9], v[8:9], s[62:63]
  v_cvt_pk_bf16_f32 v153, v8, v9
  v_lshlrev_b32 v8, 16, v154
  v_and_b32 v9, s26, v154
  v_pk_mul_f32 v[8:9], v[8:9], s[62:63]
  v_cvt_pk_bf16_f32 v154, v8, v9
  v_lshlrev_b32 v8, 16, v155
  v_and_b32 v9, s26, v155
  v_pk_mul_f32 v[8:9], v[8:9], s[62:63]
  v_cvt_pk_bf16_f32 v155, v8, v9
  v_mfma_f32_16x16x32_bf16 v[92:95], a[220:223], v[196:199], v[92:95]
  ds_write_b128 v31, v[152:155] offset:18432
  v_mfma_f32_16x16x32_bf16 v[160:163], a[64:67], a[32:35], v[240:243]
  s_waitcnt lgkmcnt(2)
  v_exp_f32 v176, v176
  v_mfma_f32_16x16x32_bf16 v[160:163], a[72:75], a[36:39], v[160:163]
  v_exp_f32 v177, v177
  v_mfma_f32_16x16x32_bf16 v[160:163], a[80:83], a[40:43], v[160:163]
  s_add_u32 m0, s24, 40960
  v_exp_f32 v178, v178
  v_mfma_f32_16x16x32_bf16 v[160:163], a[88:91], a[44:47], v[160:163]
  buffer_load_dwordx4 v6, s[12:15], s37 offen offset:0 nt lds
  v_cvt_pk_bf16_f32 v200, v176, v177
  v_mfma_f32_16x16x32_bf16 v[164:167], a[92:95], a[44:47], v[240:243]
  v_exp_f32 v179, v179
  v_mfma_f32_16x16x32_bf16 v[164:167], a[84:87], a[40:43], v[164:167]
  v_exp_f32 v180, v180
  s_waitcnt vmcnt(5)
  v_lshlrev_b32 v8, 16, v156
  v_and_b32 v9, s26, v156
  v_pk_mul_f32 v[8:9], v[8:9], s[62:63]
  v_cvt_pk_bf16_f32 v156, v8, v9
  v_lshlrev_b32 v8, 16, v157
  v_and_b32 v9, s26, v157
  v_pk_mul_f32 v[8:9], v[8:9], s[62:63]
  v_cvt_pk_bf16_f32 v157, v8, v9
  v_lshlrev_b32 v8, 16, v158
  v_and_b32 v9, s26, v158
  v_pk_mul_f32 v[8:9], v[8:9], s[62:63]
  v_cvt_pk_bf16_f32 v158, v8, v9
  v_lshlrev_b32 v8, 16, v159
  v_and_b32 v9, s26, v159
  v_pk_mul_f32 v[8:9], v[8:9], s[62:63]
  v_cvt_pk_bf16_f32 v159, v8, v9
  ds_write_b128 v31, v[156:159] offset:19456
  ds_read_b128 a[48:51], v29 offset:16384
  ds_read_b128 a[52:55], v29 offset:16640
  ds_read_b128 a[56:59], v29 offset:16896
  ds_read_b128 a[60:63], v29 offset:17152
  v_mfma_f32_16x16x32_bf16 v[164:167], a[76:79], a[36:39], v[164:167]
  v_exp_f32 v181, v181
  v_mfma_f32_16x16x32_bf16 v[164:167], a[68:71], a[32:35], v[164:167]
  s_waitcnt lgkmcnt(3)
  buffer_load_dwordx4 v6, s[12:15], s37 offen offset:1024 nt lds
  v_cvt_pk_bf16_f32 v201, v178, v179
  v_mfma_f32_16x16x32_bf16 v[172:175], a[68:71], a[48:51], v[240:243]
  s_waitcnt vmcnt(4) lgkmcnt(2)
  s_barrier
  v_cvt_pk_bf16_f32 v202, v180, v181
  v_mfma_f32_16x16x32_bf16 v[172:175], a[76:79], a[52:55], v[172:175]
  s_waitcnt lgkmcnt(1)
  ds_read_b64_tr_b16 a[224:225], v4 offset:57344
  ds_read_b64_tr_b16 a[226:227], v4 offset:58368
  ds_read_b64_tr_b16 a[228:229], v4 offset:57352
  ds_read_b64_tr_b16 a[230:231], v4 offset:58376
  v_mfma_f32_16x16x32_bf16 v[172:175], a[84:87], a[56:59], v[172:175]
  s_waitcnt lgkmcnt(4)
  ds_read_b64_tr_b16 a[232:233], v4 offset:57600
  ds_read_b64_tr_b16 a[234:235], v4 offset:58624
  v_mfma_f32_16x16x32_bf16 v[172:175], a[92:95], a[60:63], v[172:175]
  v_exp_f32 v182, v182
  v_mfma_f32_16x16x32_bf16 v[168:171], a[88:91], a[60:63], v[240:243]
  v_exp_f32 v183, v183
  v_mfma_f32_16x16x32_bf16 v[168:171], a[80:83], a[56:59], v[168:171]
  ds_read_b64_tr_b16 a[236:237], v4 offset:57608
  ds_read_b64_tr_b16 a[238:239], v4 offset:58632
  v_mfma_f32_16x16x32_bf16 v[168:171], a[72:75], a[52:55], v[168:171]
  v_cvt_pk_bf16_f32 v203, v182, v183
  v_exp_f32 v184, v184
  v_exp_f32 v185, v185
  v_exp_f32 v186, v186
  v_exp_f32 v187, v187
  v_exp_f32 v188, v188
  v_exp_f32 v189, v189
  v_exp_f32 v190, v190
  v_exp_f32 v191, v191
  v_mfma_f32_16x16x32_bf16 v[168:171], a[64:67], a[48:51], v[168:171]
  s_waitcnt lgkmcnt(4)
  ds_read_b64_tr_b16 a[240:241], v4 offset:57856
  ds_read_b64_tr_b16 a[242:243], v4 offset:58880
  v_cvt_pk_bf16_f32 v204, v184, v185
  v_cvt_pk_bf16_f32 v205, v186, v187
  v_cvt_pk_bf16_f32 v206, v188, v189
  v_cvt_pk_bf16_f32 v207, v190, v191
  v_mfma_f32_16x16x32_bf16 v[32:35], a[224:227], v[200:203], v[32:35]
  ds_read_b64_tr_b16 a[244:245], v4 offset:57864
  ds_read_b64_tr_b16 a[246:247], v4 offset:58888
  v_mfma_f32_16x16x32_bf16 v[40:43], a[224:227], v[204:207], v[40:43]
  ds_read_b64_tr_b16 a[248:249], v4 offset:58112
  ds_read_b64_tr_b16 a[250:251], v4 offset:59136
  v_mfma_f32_16x16x32_bf16 v[36:39], a[228:231], v[200:203], v[36:39]
  ds_read_b64_tr_b16 a[252:253], v4 offset:58120
  ds_read_b64_tr_b16 a[254:255], v4 offset:59144
  v_mfma_f32_16x16x32_bf16 v[44:47], a[228:231], v[204:207], v[44:47]
  ds_read_b128 a[64:67], v2 offset:16384
  ds_read_b128 a[72:75], v2 offset:16640
  v_smfmac_f32_16x16x64_bf16 v[14:17], v[10:13], v[200:207], v0
  s_waitcnt lgkmcnt(10)
  ds_read_b128 a[80:83], v2 offset:16896
  v_mfma_f32_16x16x32_bf16 v[48:51], a[232:235], v[200:203], v[48:51]
  s_add_u32 m0, s24, 98304
  ds_read_b128 a[88:91], v2 offset:17152
  ds_read_b128 a[92:95], v2 offset:18176
  v_mfma_f32_16x16x32_bf16 v[56:59], a[232:235], v[204:207], v[56:59]
  buffer_load_dwordx4 v7, s[16:19], s36 offen offset:0 nt lds
  ds_read_b128 a[84:87], v2 offset:17920
  v_mfma_f32_16x16x32_bf16 v[52:55], a[236:239], v[200:203], v[52:55]
  ds_read_b128 a[76:79], v2 offset:17664
  ds_read_b128 a[68:71], v2 offset:17408
  v_mfma_f32_16x16x32_bf16 v[60:63], a[236:239], v[204:207], v[60:63]
  s_waitcnt lgkmcnt(8)
  v_exp_f32 v160, v160
  v_mfma_f32_16x16x32_bf16 v[64:67], a[240:243], v[200:203], v[64:67]
  v_exp_f32 v161, v161
  v_mfma_f32_16x16x32_bf16 v[72:75], a[240:243], v[204:207], v[72:75]
  buffer_load_dwordx4 v7, s[16:19], s36 offen offset:1024 nt lds
  v_cvt_pk_bf16_f32 v192, v160, v161
  v_mfma_f32_16x16x32_bf16 v[68:71], a[244:247], v[200:203], v[68:71]
  v_exp_f32 v162, v162
  v_mfma_f32_16x16x32_bf16 v[76:79], a[244:247], v[204:207], v[76:79]
  v_exp_f32 v163, v163
  v_mfma_f32_16x16x32_bf16 v[80:83], a[248:251], v[200:203], v[80:83]
  v_exp_f32 v164, v164
  v_mfma_f32_16x16x32_bf16 v[88:91], a[248:251], v[204:207], v[88:91]
  v_exp_f32 v165, v165
  v_mfma_f32_16x16x32_bf16 v[84:87], a[252:255], v[200:203], v[84:87]
  v_exp_f32 v166, v166
  v_mfma_f32_16x16x32_bf16 v[92:95], a[252:255], v[204:207], v[92:95]
  s_waitcnt lgkmcnt(0)
  v_exp_f32 v167, v167
  v_mfma_f32_16x16x32_bf16 v[176:179], a[64:67], a[32:35], v[240:243]
  v_exp_f32 v168, v168
  v_mfma_f32_16x16x32_bf16 v[176:179], a[72:75], a[36:39], v[176:179]
  v_exp_f32 v169, v169
  v_mfma_f32_16x16x32_bf16 v[176:179], a[80:83], a[40:43], v[176:179]
  v_exp_f32 v170, v170
  v_mfma_f32_16x16x32_bf16 v[176:179], a[88:91], a[44:47], v[176:179]
L_t1:
  s_cbranch_vccnz L_t5
  v_exp_f32 v171, v171
  v_mfma_f32_16x16x32_bf16 v[180:183], a[92:95], a[44:47], v[240:243]
  v_exp_f32 v172, v172
  v_mfma_f32_16x16x32_bf16 v[180:183], a[84:87], a[40:43], v[180:183]
  v_exp_f32 v173, v173
  v_mfma_f32_16x16x32_bf16 v[180:183], a[76:79], a[36:39], v[180:183]
  v_exp_f32 v174, v174
  v_mfma_f32_16x16x32_bf16 v[180:183], a[68:71], a[32:35], v[180:183]
  v_exp_f32 v175, v175
  v_mfma_f32_16x16x32_bf16 v[188:191], a[68:71], a[48:51], v[240:243]
  ds_read_b128 a[68:71], v2 offset:1024
  v_cvt_pk_bf16_f32 v193, v162, v163
  v_mfma_f32_16x16x32_bf16 v[188:191], a[76:79], a[52:55], v[188:191]
  ds_read_b128 a[76:79], v2 offset:1280
  v_cvt_pk_bf16_f32 v194, v164, v165
  v_mfma_f32_16x16x32_bf16 v[188:191], a[84:87], a[56:59], v[188:191]
  ds_read_b128 a[84:87], v2 offset:1536
  v_cvt_pk_bf16_f32 v195, v166, v167
  v_mfma_f32_16x16x32_bf16 v[188:191], a[92:95], a[60:63], v[188:191]
  ds_read_b128 a[92:95], v2 offset:1792
  v_cvt_pk_bf16_f32 v196, v168, v169
  v_mfma_f32_16x16x32_bf16 v[184:187], a[88:91], a[60:63], v[240:243]
  ds_read_b128 a[88:91], v2 offset:768
  v_cvt_pk_bf16_f32 v197, v170, v171
  v_mfma_f32_16x16x32_bf16 v[184:187], a[80:83], a[56:59], v[184:187]
  ds_read_b128 a[80:83], v2 offset:512
  v_cvt_pk_bf16_f32 v198, v172, v173
  v_mfma_f32_16x16x32_bf16 v[184:187], a[72:75], a[52:55], v[184:187]
  ds_read_b128 a[72:75], v2 offset:256
  v_cvt_pk_bf16_f32 v199, v174, v175
  v_mfma_f32_16x16x32_bf16 v[184:187], a[64:67], a[48:51], v[184:187]
  ds_read_b128 a[64:67], v2 offset:0
  v_mov_b32 v28, 0
  v_mfma_f32_16x16x32_bf16 v[96:99], a[224:227], v[192:195], 0
  v_exp_f32 v176, v176
  v_mfma_f32_16x16x32_bf16 v[104:107], a[224:227], v[196:199], 0
  v_exp_f32 v177, v177
  v_mfma_f32_16x16x32_bf16 v[100:103], a[228:231], v[192:195], 0
  v_exp_f32 v178, v178
  v_mfma_f32_16x16x32_bf16 v[108:111], a[228:231], v[196:199], 0
  v_exp_f32 v179, v179
  v_smfmac_f32_16x16x64_bf16 v[20:23], v[10:13], v[192:199], v0
  v_cvt_pk_bf16_f32 v200, v176, v177
  v_mfma_f32_16x16x32_bf16 v[112:115], a[232:235], v[192:195], 0
  v_exp_f32 v180, v180
  v_mfma_f32_16x16x32_bf16 v[120:123], a[232:235], v[196:199], 0
  v_exp_f32 v181, v181
  v_mfma_f32_16x16x32_bf16 v[116:119], a[236:239], v[192:195], 0
  s_add_u32 m0, s24, 49152
  v_exp_f32 v182, v182
  v_mfma_f32_16x16x32_bf16 v[124:127], a[236:239], v[196:199], 0
  buffer_load_dwordx4 v6, s[12:15], s38 offen offset:0 nt lds
  v_cvt_pk_bf16_f32 v201, v178, v179
  v_mfma_f32_16x16x32_bf16 v[128:131], a[240:243], v[192:195], 0
  v_exp_f32 v183, v183
  v_mfma_f32_16x16x32_bf16 v[136:139], a[240:243], v[196:199], 0
  v_exp_f32 v184, v184
  v_mfma_f32_16x16x32_bf16 v[132:135], a[244:247], v[192:195], 0
  v_exp_f32 v185, v185
  v_mfma_f32_16x16x32_bf16 v[140:143], a[244:247], v[196:199], 0
  buffer_load_dwordx4 v6, s[12:15], s38 offen offset:1024 nt lds
  v_cvt_pk_bf16_f32 v202, v180, v181
  v_mfma_f32_16x16x32_bf16 v[144:147], a[248:251], v[192:195], 0
  v_exp_f32 v186, v186
  v_mfma_f32_16x16x32_bf16 v[152:155], a[248:251], v[196:199], 0
  v_exp_f32 v187, v187
  v_mfma_f32_16x16x32_bf16 v[148:151], a[252:255], v[192:195], 0
  v_exp_f32 v188, v188
  v_mfma_f32_16x16x32_bf16 v[156:159], a[252:255], v[196:199], 0
  v_exp_f32 v189, v189
  v_mfma_f32_16x16x32_bf16 v[160:163], a[96:99], a[32:35], v[240:243]
  v_exp_f32 v190, v190
  v_mfma_f32_16x16x32_bf16 v[160:163], a[104:107], a[36:39], v[160:163]
  v_exp_f32 v191, v191
  v_mfma_f32_16x16x32_bf16 v[160:163], a[112:115], a[40:43], v[160:163]
  v_cvt_pk_bf16_f32 v203, v182, v183
  v_cvt_pk_bf16_f32 v204, v184, v185
  v_mfma_f32_16x16x32_bf16 v[160:163], a[120:123], a[44:47], v[160:163]
  v_cvt_pk_bf16_f32 v205, v186, v187
  v_cvt_pk_bf16_f32 v206, v188, v189
  v_mfma_f32_16x16x32_bf16 v[164:167], a[124:127], a[44:47], v[240:243]
  v_cvt_pk_bf16_f32 v207, v190, v191
  v_mov_b32 v29, 0
  v_mfma_f32_16x16x32_bf16 v[164:167], a[116:119], a[40:43], v[164:167]
  v_mov_b32 v30, 0
  v_mov_b32 v31, 0
  v_mfma_f32_16x16x32_bf16 v[164:167], a[108:111], a[36:39], v[164:167]
  v_exp_f32 v160, v160
  v_mfma_f32_16x16x32_bf16 v[164:167], a[100:103], a[32:35], v[164:167]
  s_waitcnt lgkmcnt(0)
  v_exp_f32 v161, v161
  v_mfma_f32_16x16x32_bf16 v[172:175], a[68:71], a[32:35], v[240:243]
  s_add_u32 m0, s24, 106496
  v_exp_f32 v162, v162
  v_mfma_f32_16x16x32_bf16 v[172:175], a[76:79], a[36:39], v[172:175]
  buffer_load_dwordx4 v7, s[16:19], s37 offen offset:0 nt lds
  v_cvt_pk_bf16_f32 v192, v160, v161
  v_mfma_f32_16x16x32_bf16 v[172:175], a[84:87], a[40:43], v[172:175]
  v_exp_f32 v163, v163
  v_mfma_f32_16x16x32_bf16 v[172:175], a[92:95], a[44:47], v[172:175]
  v_exp_f32 v164, v164
  v_mfma_f32_16x16x32_bf16 v[168:171], a[88:91], a[44:47], v[240:243]
  v_exp_f32 v165, v165
  v_mfma_f32_16x16x32_bf16 v[168:171], a[80:83], a[40:43], v[168:171]
  buffer_load_dwordx4 v7, s[16:19], s37 offen offset:1024 nt lds
  v_cvt_pk_bf16_f32 v193, v162, v163
  v_mfma_f32_16x16x32_bf16 v[168:171], a[72:75], a[36:39], v[168:171]
  v_exp_f32 v166, v166
  v_mfma_f32_16x16x32_bf16 v[168:171], a[64:67], a[32:35], v[168:171]
  v_exp_f32 v167, v167
  v_mfma_f32_16x16x32_bf16 v[96:99], a[192:195], v[200:203], v[96:99]
  v_exp_f32 v172, v172
  v_mfma_f32_16x16x32_bf16 v[104:107], a[192:195], v[204:207], v[104:107]
  v_exp_f32 v173, v173
  v_mfma_f32_16x16x32_bf16 v[100:103], a[196:199], v[200:203], v[100:103]
  v_exp_f32 v168, v168
  v_mfma_f32_16x16x32_bf16 v[108:111], a[196:199], v[204:207], v[108:111]
  v_exp_f32 v169, v169
  v_smfmac_f32_16x16x64_bf16 v[20:23], v[10:13], v[200:207], v0
  v_cvt_pk_bf16_f32 v194, v164, v165
  v_mfma_f32_16x16x32_bf16 v[112:115], a[200:203], v[200:203], v[112:115]
  v_exp_f32 v170, v170
  v_mfma_f32_16x16x32_bf16 v[120:123], a[200:203], v[204:207], v[120:123]
  v_exp_f32 v171, v171
  v_mfma_f32_16x16x32_bf16 v[116:119], a[204:207], v[200:203], v[116:119]
  v_exp_f32 v174, v174
  v_mfma_f32_16x16x32_bf16 v[124:127], a[204:207], v[204:207], v[124:127]
  v_exp_f32 v175, v175
  v_mfma_f32_16x16x32_bf16 v[128:131], a[208:211], v[200:203], v[128:131]
  v_cvt_pk_bf16_f32 v195, v166, v167
  v_cvt_pk_bf16_f32 v196, v168, v169
  v_mfma_f32_16x16x32_bf16 v[136:139], a[208:211], v[204:207], v[136:139]
  v_cvt_pk_bf16_f32 v197, v170, v171
  v_cvt_pk_bf16_f32 v198, v172, v173
  v_mfma_f32_16x16x32_bf16 v[132:135], a[212:215], v[200:203], v[132:135]
  s_add_u32 m0, s24, 57344
  v_cvt_pk_bf16_f32 v199, v174, v175
  v_mfma_f32_16x16x32_bf16 v[140:143], a[212:215], v[204:207], v[140:143]
  buffer_load_dwordx4 v6, s[12:15], s39 offen offset:0 nt lds
  v_mfma_f32_16x16x32_bf16 v[144:147], a[216:219], v[200:203], v[144:147]
  v_mfma_f32_16x16x32_bf16 v[152:155], a[216:219], v[204:207], v[152:155]
  v_mfma_f32_16x16x32_bf16 v[148:151], a[220:223], v[200:203], v[148:151]
  v_mfma_f32_16x16x32_bf16 v[156:159], a[220:223], v[204:207], v[156:159]
  buffer_load_dwordx4 v6, s[12:15], s39 offen offset:1024 nt lds
  v_mfma_f32_16x16x32_bf16 v[176:179], a[96:99], a[48:51], v[240:243]
  v_mfma_f32_16x16x32_bf16 v[176:179], a[104:107], a[52:55], v[176:179]
  v_mfma_f32_16x16x32_bf16 v[176:179], a[112:115], a[56:59], v[176:179]
  v_mfma_f32_16x16x32_bf16 v[176:179], a[120:123], a[60:63], v[176:179]
  v_mfma_f32_16x16x32_bf16 v[180:183], a[124:127], a[60:63], v[240:243]
  v_mfma_f32_16x16x32_bf16 v[180:183], a[116:119], a[56:59], v[180:183]
  v_mfma_f32_16x16x32_bf16 v[180:183], a[108:111], a[52:55], v[180:183]
  v_exp_f32 v176, v176
  v_mfma_f32_16x16x32_bf16 v[180:183], a[100:103], a[48:51], v[180:183]
  v_exp_f32 v177, v177
  v_mfma_f32_16x16x32_bf16 v[188:191], a[68:71], a[48:51], v[240:243]
  v_exp_f32 v178, v178
  v_mfma_f32_16x16x32_bf16 v[188:191], a[76:79], a[52:55], v[188:191]
  v_exp_f32 v179, v179
  v_mfma_f32_16x16x32_bf16 v[188:191], a[84:87], a[56:59], v[188:191]
  v_exp_f32 v180, v180
  v_mfma_f32_16x16x32_bf16 v[188:191], a[92:95], a[60:63], v[188:191]
  v_exp_f32 v181, v181
  v_mfma_f32_16x16x32_bf16 v[184:187], a[88:91], a[60:63], v[240:243]
  s_add_u32 m0, s24, 114688
  v_exp_f32 v182, v182
  v_mfma_f32_16x16x32_bf16 v[184:187], a[80:83], a[56:59], v[184:187]
  buffer_load_dwordx4 v7, s[16:19], s38 offen offset:0 nt lds
  v_cvt_pk_bf16_f32 v200, v176, v177
  v_mfma_f32_16x16x32_bf16 v[184:187], a[72:75], a[52:55], v[184:187]
  v_exp_f32 v183, v183
  v_mfma_f32_16x16x32_bf16 v[184:187], a[64:67], a[48:51], v[184:187]
  v_exp_f32 v188, v188
  v_mfma_f32_16x16x32_bf16 v[96:99], a[160:163], v[192:195], v[96:99]
  v_exp_f32 v189, v189
  v_mfma_f32_16x16x32_bf16 v[96:99], a[128:131], v[196:199], v[96:99]
  buffer_load_dwordx4 v7, s[16:19], s38 offen offset:1024 nt lds
  v_cvt_pk_bf16_f32 v201, v178, v179
  v_mfma_f32_16x16x32_bf16 v[100:103], a[164:167], v[192:195], v[100:103]
  v_exp_f32 v184, v184
  v_mfma_f32_16x16x32_bf16 v[100:103], a[132:135], v[196:199], v[100:103]
  v_exp_f32 v185, v185
  v_smfmac_f32_16x16x64_bf16 v[18:21], v[10:13], v[192:199], v0
  v_cvt_pk_bf16_f32 v202, v180, v181
  v_mfma_f32_16x16x32_bf16 v[112:115], a[168:171], v[192:195], v[112:115]
  v_exp_f32 v186, v186
  v_mfma_f32_16x16x32_bf16 v[112:115], a[136:139], v[196:199], v[112:115]
  v_exp_f32 v187, v187
  v_mfma_f32_16x16x32_bf16 v[116:119], a[172:175], v[192:195], v[116:119]
  v_exp_f32 v190, v190
  v_mfma_f32_16x16x32_bf16 v[116:119], a[140:143], v[196:199], v[116:119]
  v_exp_f32 v191, v191
  v_mfma_f32_16x16x32_bf16 v[128:131], a[176:179], v[192:195], v[128:131]
  s_waitcnt vmcnt(12)
  s_barrier
  v_cvt_pk_bf16_f32 v203, v182, v183
  v_mfma_f32_16x16x32_bf16 v[128:131], a[144:147], v[196:199], v[128:131]
  ds_read_b128 a[96:99], v2 offset:32768
  ds_read_b128 a[104:107], v2 offset:33024
  ds_read_b128 a[112:115], v2 offset:33280
  ds_read_b128 a[120:123], v2 offset:33536
  v_mfma_f32_16x16x32_bf16 v[132:135], a[180:183], v[192:195], v[132:135]
  ds_read_b128 a[124:127], v2 offset:34560
  ds_read_b128 a[116:119], v2 offset:34304
  v_mfma_f32_16x16x32_bf16 v[132:135], a[148:151], v[196:199], v[132:135]
  ds_read_b128 a[108:111], v2 offset:34048
  ds_read_b128 a[100:103], v2 offset:33792
  v_mfma_f32_16x16x32_bf16 v[144:147], a[184:187], v[192:195], v[144:147]
  v_cvt_pk_bf16_f32 v204, v184, v185
  v_cvt_pk_bf16_f32 v205, v186, v187
  v_mfma_f32_16x16x32_bf16 v[144:147], a[152:155], v[196:199], v[144:147]
  v_cvt_pk_bf16_f32 v206, v188, v189
  v_cvt_pk_bf16_f32 v207, v190, v191
  v_mfma_f32_16x16x32_bf16 v[148:151], a[188:191], v[192:195], v[148:151]
  v_mfma_f32_16x16x32_bf16 v[148:151], a[156:159], v[196:199], v[148:151]
  s_waitcnt lgkmcnt(4)
  v_mfma_f32_16x16x32_bf16 v[160:163], a[96:99], a[0:3], v[240:243]
  v_mfma_f32_16x16x32_bf16 v[160:163], a[104:107], a[4:7], v[160:163]
  v_mfma_f32_16x16x32_bf16 v[160:163], a[112:115], a[8:11], v[160:163]
  v_mfma_f32_16x16x32_bf16 v[160:163], a[120:123], a[12:15], v[160:163]
  s_waitcnt lgkmcnt(0)
  v_mfma_f32_16x16x32_bf16 v[164:167], a[124:127], a[12:15], v[240:243]
  v_mfma_f32_16x16x32_bf16 v[164:167], a[116:119], a[8:11], v[164:167]
  v_mfma_f32_16x16x32_bf16 v[164:167], a[108:111], a[4:7], v[164:167]
  v_exp_f32 v160, v160
  v_mfma_f32_16x16x32_bf16 v[164:167], a[100:103], a[0:3], v[164:167]
  v_exp_f32 v161, v161
  v_mfma_f32_16x16x32_bf16 v[172:175], a[100:103], a[16:19], v[240:243]
  v_exp_f32 v162, v162
  v_mfma_f32_16x16x32_bf16 v[172:175], a[108:111], a[20:23], v[172:175]
  v_exp_f32 v163, v163
  v_mfma_f32_16x16x32_bf16 v[172:175], a[116:119], a[24:27], v[172:175]
  v_exp_f32 v164, v164
  v_mfma_f32_16x16x32_bf16 v[172:175], a[124:127], a[28:31], v[172:175]
  v_exp_f32 v165, v165
  v_mfma_f32_16x16x32_bf16 v[168:171], a[120:123], a[28:31], v[240:243]
  v_exp_f32 v166, v166
  v_mfma_f32_16x16x32_bf16 v[168:171], a[112:115], a[24:27], v[168:171]
  v_exp_f32 v167, v167
  v_mfma_f32_16x16x32_bf16 v[168:171], a[104:107], a[20:23], v[168:171]
  s_waitcnt vmcnt(8)
  s_barrier
  v_cvt_pk_bf16_f32 v192, v160, v161
  v_mfma_f32_16x16x32_bf16 v[168:171], a[96:99], a[16:19], v[168:171]
  ds_read_b64_tr_b16 a[64:65], v4 offset:0
  ds_read_b64_tr_b16 a[66:67], v4 offset:1024
  v_mfma_f32_16x16x32_bf16 v[104:107], a[160:163], v[200:203], v[104:107]
  ds_read_b64_tr_b16 a[68:69], v4 offset:8
  ds_read_b64_tr_b16 a[70:71], v4 offset:1032
  v_mfma_f32_16x16x32_bf16 v[104:107], a[128:131], v[204:207], v[104:107]
  ds_read_b64_tr_b16 a[72:73], v4 offset:256
  ds_read_b64_tr_b16 a[74:75], v4 offset:1280
  v_mfma_f32_16x16x32_bf16 v[108:111], a[164:167], v[200:203], v[108:111]
  ds_read_b64_tr_b16 a[76:77], v4 offset:264
  ds_read_b64_tr_b16 a[78:79], v4 offset:1288
  v_mfma_f32_16x16x32_bf16 v[108:111], a[132:135], v[204:207], v[108:111]
  v_exp_f32 v168, v168
  v_smfmac_f32_16x16x64_bf16 v[22:25], v[10:13], v[200:207], v0
  v_cvt_pk_bf16_f32 v193, v162, v163
  v_mfma_f32_16x16x32_bf16 v[120:123], a[168:171], v[200:203], v[120:123]
  v_exp_f32 v169, v169
  v_mfma_f32_16x16x32_bf16 v[120:123], a[136:139], v[204:207], v[120:123]
  v_exp_f32 v170, v170
  v_mfma_f32_16x16x32_bf16 v[124:127], a[172:175], v[200:203], v[124:127]
  v_exp_f32 v171, v171
  v_mfma_f32_16x16x32_bf16 v[124:127], a[140:143], v[204:207], v[124:127]
  v_exp_f32 v172, v172
  v_mfma_f32_16x16x32_bf16 v[136:139], a[176:179], v[200:203], v[136:139]
  v_exp_f32 v173, v173
  v_mfma_f32_16x16x32_bf16 v[136:139], a[144:147], v[204:207], v[136:139]
  v_exp_f32 v174, v174
  v_mfma_f32_16x16x32_bf16 v[140:143], a[180:183], v[200:203], v[140:143]
  v_exp_f32 v175, v175
  v_mfma_f32_16x16x32_bf16 v[140:143], a[148:151], v[204:207], v[140:143]
  ds_read_b64_tr_b16 a[80:81], v4 offset:512
  v_cvt_pk_bf16_f32 v194, v164, v165
  v_mfma_f32_16x16x32_bf16 v[152:155], a[184:187], v[200:203], v[152:155]
  ds_read_b64_tr_b16 a[82:83], v4 offset:1536
  v_cvt_pk_bf16_f32 v195, v166, v167
  v_mfma_f32_16x16x32_bf16 v[152:155], a[152:155], v[204:207], v[152:155]
  ds_read_b64_tr_b16 a[84:85], v4 offset:520
  v_cvt_pk_bf16_f32 v196, v168, v169
  v_mfma_f32_16x16x32_bf16 v[156:159], a[188:191], v[200:203], v[156:159]
  ds_read_b64_tr_b16 a[86:87], v4 offset:1544
  v_cvt_pk_bf16_f32 v197, v170, v171
  v_mfma_f32_16x16x32_bf16 v[156:159], a[156:159], v[204:207], v[156:159]
  ds_read_b64_tr_b16 a[88:89], v4 offset:768
  v_cvt_pk_bf16_f32 v198, v172, v173
  v_mfma_f32_16x16x32_bf16 v[176:179], a[96:99], a[32:35], v[240:243]
  s_add_u32 m0, s24, 65536
  ds_read_b64_tr_b16 a[90:91], v4 offset:1792
  v_cvt_pk_bf16_f32 v199, v174, v175
  v_mfma_f32_16x16x32_bf16 v[176:179], a[104:107], a[36:39], v[176:179]
  buffer_load_dwordx4 v6, s[12:15], s40 offen offset:0 nt lds
  ds_read_b64_tr_b16 a[92:93], v4 offset:776
  v_mfma_f32_16x16x32_bf16 v[176:179], a[112:115], a[40:43], v[176:179]
  ds_read_b64_tr_b16 a[94:95], v4 offset:1800
  v_mfma_f32_16x16x32_bf16 v[176:179], a[120:123], a[44:47], v[176:179]
  v_mfma_f32_16x16x32_bf16 v[180:183], a[124:127], a[44:47], v[240:243]
  v_mfma_f32_16x16x32_bf16 v[180:183], a[116:119], a[40:43], v[180:183]
  buffer_load_dwordx4 v6, s[12:15], s40 offen offset:1024 nt lds
  v_mfma_f32_16x16x32_bf16 v[180:183], a[108:111], a[36:39], v[180:183]
  v_exp_f32 v176, v176
  v_mfma_f32_16x16x32_bf16 v[180:183], a[100:103], a[32:35], v[180:183]
  v_exp_f32 v177, v177
  v_mfma_f32_16x16x32_bf16 v[188:191], a[100:103], a[48:51], v[240:243]
  ds_read_b128 a[100:103], v2 offset:41984
  v_cvt_pk_bf16_f32 v200, v176, v177
  v_mfma_f32_16x16x32_bf16 v[188:191], a[108:111], a[52:55], v[188:191]
  v_exp_f32 v178, v178
  v_mfma_f32_16x16x32_bf16 v[188:191], a[116:119], a[56:59], v[188:191]
  ds_read_b128 a[116:119], v2 offset:42496
  ds_read_b128 a[108:111], v2 offset:42240
  v_mfma_f32_16x16x32_bf16 v[188:191], a[124:127], a[60:63], v[188:191]
  v_exp_f32 v179, v179
  v_mfma_f32_16x16x32_bf16 v[184:187], a[120:123], a[60:63], v[240:243]
  ds_read_b128 a[120:123], v2 offset:41728
  ds_read_b128 a[124:127], v2 offset:42752
  v_mfma_f32_16x16x32_bf16 v[184:187], a[112:115], a[56:59], v[184:187]
  ds_read_b128 a[112:115], v2 offset:41472
  v_cvt_pk_bf16_f32 v201, v178, v179
  v_mfma_f32_16x16x32_bf16 v[184:187], a[104:107], a[52:55], v[184:187]
  v_exp_f32 v180, v180
  v_mfma_f32_16x16x32_bf16 v[184:187], a[96:99], a[48:51], v[184:187]
  s_waitcnt lgkmcnt(5)
  ds_read_b128 a[96:99], v2 offset:40960
  ds_read_b128 a[104:107], v2 offset:41216
  v_mfma_f32_16x16x32_bf16 v[32:35], a[64:67], v[192:195], v[32:35]
  v_exp_f32 v181, v181
  v_mfma_f32_16x16x32_bf16 v[40:43], a[64:67], v[196:199], v[40:43]
  v_exp_f32 v182, v182
  v_mfma_f32_16x16x32_bf16 v[36:39], a[68:71], v[192:195], v[36:39]
  v_exp_f32 v183, v183
  v_mfma_f32_16x16x32_bf16 v[44:47], a[68:71], v[196:199], v[44:47]
  buffer_load_dwordx4 v[208:211], v1, s[8:11], s30 offen offset:0 nt
  v_cvt_pk_bf16_f32 v202, v180, v181
  v_smfmac_f32_16x16x64_bf16 v[14:17], v[10:13], v[192:199], v0
  v_cvt_pk_bf16_f32 v203, v182, v183
  v_mfma_f32_16x16x32_bf16 v[48:51], a[72:75], v[192:195], v[48:51]
  v_exp_f32 v184, v184
  v_mfma_f32_16x16x32_bf16 v[56:59], a[72:75], v[196:199], v[56:59]
  v_exp_f32 v185, v185
  v_mfma_f32_16x16x32_bf16 v[52:55], a[76:79], v[192:195], v[52:55]
  v_exp_f32 v186, v186
  v_mfma_f32_16x16x32_bf16 v[60:63], a[76:79], v[196:199], v[60:63]
  v_exp_f32 v187, v187
  v_mfma_f32_16x16x32_bf16 v[64:67], a[80:83], v[192:195], v[64:67]
  v_exp_f32 v188, v188
  v_mfma_f32_16x16x32_bf16 v[72:75], a[80:83], v[196:199], v[72:75]
  v_exp_f32 v189, v189
  v_mfma_f32_16x16x32_bf16 v[68:71], a[84:87], v[192:195], v[68:71]
  v_exp_f32 v190, v190
  v_mfma_f32_16x16x32_bf16 v[76:79], a[84:87], v[196:199], v[76:79]
  v_exp_f32 v191, v191
  v_mfma_f32_16x16x32_bf16 v[80:83], a[88:91], v[192:195], v[80:83]
  v_cvt_pk_bf16_f32 v204, v184, v185
  v_cvt_pk_bf16_f32 v205, v186, v187
  v_mfma_f32_16x16x32_bf16 v[88:91], a[88:91], v[196:199], v[88:91]
  v_cvt_pk_bf16_f32 v206, v188, v189
  v_cvt_pk_bf16_f32 v207, v190, v191
  v_mfma_f32_16x16x32_bf16 v[84:87], a[92:95], v[192:195], v[84:87]
  v_mfma_f32_16x16x32_bf16 v[92:95], a[92:95], v[196:199], v[92:95]
  s_waitcnt lgkmcnt(0)
  v_mfma_f32_16x16x32_bf16 v[160:163], a[96:99], a[0:3], v[240:243]
  s_add_u32 m0, s24, 122880
  v_mfma_f32_16x16x32_bf16 v[160:163], a[104:107], a[4:7], v[160:163]
  buffer_load_dwordx4 v7, s[16:19], s39 offen offset:0 nt lds
  v_mfma_f32_16x16x32_bf16 v[160:163], a[112:115], a[8:11], v[160:163]
  v_mfma_f32_16x16x32_bf16 v[160:163], a[120:123], a[12:15], v[160:163]
  v_mfma_f32_16x16x32_bf16 v[164:167], a[124:127], a[12:15], v[240:243]
  v_mfma_f32_16x16x32_bf16 v[164:167], a[116:119], a[8:11], v[164:167]
  buffer_load_dwordx4 v7, s[16:19], s39 offen offset:1024 nt lds
  v_mfma_f32_16x16x32_bf16 v[164:167], a[108:111], a[4:7], v[164:167]
  v_exp_f32 v160, v160
  v_mfma_f32_16x16x32_bf16 v[164:167], a[100:103], a[0:3], v[164:167]
  v_exp_f32 v161, v161
  v_mfma_f32_16x16x32_bf16 v[172:175], a[100:103], a[16:19], v[240:243]
  v_exp_f32 v162, v162
  v_mfma_f32_16x16x32_bf16 v[172:175], a[108:111], a[20:23], v[172:175]
  v_exp_f32 v163, v163
  v_mfma_f32_16x16x32_bf16 v[172:175], a[116:119], a[24:27], v[172:175]
  v_exp_f32 v164, v164
  v_mfma_f32_16x16x32_bf16 v[172:175], a[124:127], a[28:31], v[172:175]
  v_exp_f32 v165, v165
  v_mfma_f32_16x16x32_bf16 v[168:171], a[120:123], a[28:31], v[240:243]
  v_exp_f32 v166, v166
  v_mfma_f32_16x16x32_bf16 v[168:171], a[112:115], a[24:27], v[168:171]
  v_exp_f32 v167, v167
  v_mfma_f32_16x16x32_bf16 v[168:171], a[104:107], a[20:23], v[168:171]
  s_waitcnt vmcnt(5)
  s_barrier
  v_cvt_pk_bf16_f32 v192, v160, v161
  v_mfma_f32_16x16x32_bf16 v[168:171], a[96:99], a[16:19], v[168:171]
  v_exp_f32 v172, v172
  v_mfma_f32_16x16x32_bf16 v[96:99], a[64:67], v[200:203], v[96:99]
  v_exp_f32 v173, v173
  v_mfma_f32_16x16x32_bf16 v[104:107], a[64:67], v[204:207], v[104:107]
  ds_read_b64_tr_b16 a[64:65], v4 offset:8192
  ds_read_b64_tr_b16 a[66:67], v4 offset:9216
  v_mfma_f32_16x16x32_bf16 v[100:103], a[68:71], v[200:203], v[100:103]
  v_exp_f32 v168, v168
  v_mfma_f32_16x16x32_bf16 v[108:111], a[68:71], v[204:207], v[108:111]
  buffer_load_dwordx4 v[212:215], v1, s[8:11], s30 offen offset:64 nt
  ds_read_b64_tr_b16 a[68:69], v4 offset:8200
  v_smfmac_f32_16x16x64_bf16 v[20:23], v[10:13], v[200:207], v0
  ds_read_b64_tr_b16 a[70:71], v4 offset:9224
  v_mfma_f32_16x16x32_bf16 v[112:115], a[72:75], v[200:203], v[112:115]
  v_exp_f32 v169, v169
  v_mfma_f32_16x16x32_bf16 v[120:123], a[72:75], v[204:207], v[120:123]
  ds_read_b64_tr_b16 a[72:73], v4 offset:8448
  ds_read_b64_tr_b16 a[74:75], v4 offset:9472
  v_mfma_f32_16x16x32_bf16 v[116:119], a[76:79], v[200:203], v[116:119]
  v_exp_f32 v170, v170
  v_mfma_f32_16x16x32_bf16 v[124:127], a[76:79], v[204:207], v[124:127]
  ds_read_b64_tr_b16 a[76:77], v4 offset:8456
  ds_read_b64_tr_b16 a[78:79], v4 offset:9480
  v_mfma_f32_16x16x32_bf16 v[128:131], a[80:83], v[200:203], v[128:131]
  v_exp_f32 v171, v171
  v_mfma_f32_16x16x32_bf16 v[136:139], a[80:83], v[204:207], v[136:139]
  v_exp_f32 v174, v174
  v_mfma_f32_16x16x32_bf16 v[132:135], a[84:87], v[200:203], v[132:135]
  v_exp_f32 v175, v175
  v_mfma_f32_16x16x32_bf16 v[140:143], a[84:87], v[204:207], v[140:143]
  ds_read_b64_tr_b16 a[80:81], v4 offset:8704
  v_cvt_pk_bf16_f32 v193, v162, v163
  v_mfma_f32_16x16x32_bf16 v[144:147], a[88:91], v[200:203], v[144:147]
  ds_read_b64_tr_b16 a[82:83], v4 offset:9728
  v_cvt_pk_bf16_f32 v194, v164, v165
  v_mfma_f32_16x16x32_bf16 v[152:155], a[88:91], v[204:207], v[152:155]
  ds_read_b64_tr_b16 a[84:85], v4 offset:8712
  v_cvt_pk_bf16_f32 v195, v166, v167
  v_mfma_f32_16x16x32_bf16 v[148:151], a[92:95], v[200:203], v[148:151]
  ds_read_b64_tr_b16 a[86:87], v4 offset:9736
  v_cvt_pk_bf16_f32 v196, v168, v169
  v_mfma_f32_16x16x32_bf16 v[156:159], a[92:95], v[204:207], v[156:159]
  ds_read_b64_tr_b16 a[88:89], v4 offset:8960
  v_cvt_pk_bf16_f32 v197, v170, v171
  v_mfma_f32_16x16x32_bf16 v[176:179], a[96:99], a[32:35], v[240:243]
  s_add_u32 m0, s24, 73728
  ds_read_b64_tr_b16 a[90:91], v4 offset:9984
  v_cvt_pk_bf16_f32 v198, v172, v173
  v_mfma_f32_16x16x32_bf16 v[176:179], a[104:107], a[36:39], v[176:179]
  buffer_load_dwordx4 v6, s[12:15], s41 offen offset:0 nt lds
  v_cvt_pk_bf16_f32 v199, v174, v175
  v_mfma_f32_16x16x32_bf16 v[176:179], a[112:115], a[40:43], v[176:179]
  ds_read_b64_tr_b16 a[92:93], v4 offset:8968
  ds_read_b64_tr_b16 a[94:95], v4 offset:9992
  v_mfma_f32_16x16x32_bf16 v[176:179], a[120:123], a[44:47], v[176:179]
  v_mfma_f32_16x16x32_bf16 v[180:183], a[124:127], a[44:47], v[240:243]
  v_mfma_f32_16x16x32_bf16 v[180:183], a[116:119], a[40:43], v[180:183]
  buffer_load_dwordx4 v6, s[12:15], s41 offen offset:1024 nt lds
  v_mfma_f32_16x16x32_bf16 v[180:183], a[108:111], a[36:39], v[180:183]
  v_exp_f32 v176, v176
  v_mfma_f32_16x16x32_bf16 v[180:183], a[100:103], a[32:35], v[180:183]
  v_exp_f32 v177, v177
  v_mfma_f32_16x16x32_bf16 v[188:191], a[100:103], a[48:51], v[240:243]
  ds_read_b128 a[100:103], v2 offset:50176
  v_cvt_pk_bf16_f32 v200, v176, v177
  v_mfma_f32_16x16x32_bf16 v[188:191], a[108:111], a[52:55], v[188:191]
  v_exp_f32 v178, v178
  v_mfma_f32_16x16x32_bf16 v[188:191], a[116:119], a[56:59], v[188:191]
  ds_read_b128 a[116:119], v2 offset:50688
  ds_read_b128 a[108:111], v2 offset:50432
  v_mfma_f32_16x16x32_bf16 v[188:191], a[124:127], a[60:63], v[188:191]
  v_exp_f32 v179, v179
  v_mfma_f32_16x16x32_bf16 v[184:187], a[120:123], a[60:63], v[240:243]
  ds_read_b128 a[120:123], v2 offset:49920
  ds_read_b128 a[124:127], v2 offset:50944
  v_mfma_f32_16x16x32_bf16 v[184:187], a[112:115], a[56:59], v[184:187]
  ds_read_b128 a[112:115], v2 offset:49664
  v_cvt_pk_bf16_f32 v201, v178, v179
  v_mfma_f32_16x16x32_bf16 v[184:187], a[104:107], a[52:55], v[184:187]
  v_exp_f32 v180, v180
  v_mfma_f32_16x16x32_bf16 v[184:187], a[96:99], a[48:51], v[184:187]
  s_waitcnt lgkmcnt(5)
  ds_read_b128 a[96:99], v2 offset:49152
  ds_read_b128 a[104:107], v2 offset:49408
  v_mfma_f32_16x16x32_bf16 v[32:35], a[64:67], v[192:195], v[32:35]
  v_exp_f32 v181, v181
  v_mfma_f32_16x16x32_bf16 v[40:43], a[64:67], v[196:199], v[40:43]
  v_exp_f32 v182, v182
  v_mfma_f32_16x16x32_bf16 v[36:39], a[68:71], v[192:195], v[36:39]
  v_exp_f32 v183, v183
  v_mfma_f32_16x16x32_bf16 v[44:47], a[68:71], v[196:199], v[44:47]
  buffer_load_dwordx4 v[216:219], v1, s[8:11], s30 offen offset:128 nt
  v_cvt_pk_bf16_f32 v202, v180, v181
  v_smfmac_f32_16x16x64_bf16 v[14:17], v[10:13], v[192:199], v0
  v_cvt_pk_bf16_f32 v203, v182, v183
  v_mfma_f32_16x16x32_bf16 v[48:51], a[72:75], v[192:195], v[48:51]
  v_exp_f32 v184, v184
  v_mfma_f32_16x16x32_bf16 v[56:59], a[72:75], v[196:199], v[56:59]
  v_exp_f32 v185, v185
  v_mfma_f32_16x16x32_bf16 v[52:55], a[76:79], v[192:195], v[52:55]
  v_exp_f32 v186, v186
  v_mfma_f32_16x16x32_bf16 v[60:63], a[76:79], v[196:199], v[60:63]
  v_exp_f32 v187, v187
  v_mfma_f32_16x16x32_bf16 v[64:67], a[80:83], v[192:195], v[64:67]
  v_exp_f32 v188, v188
  v_mfma_f32_16x16x32_bf16 v[72:75], a[80:83], v[196:199], v[72:75]
  v_exp_f32 v189, v189
  v_mfma_f32_16x16x32_bf16 v[68:71], a[84:87], v[192:195], v[68:71]
  v_exp_f32 v190, v190
  v_mfma_f32_16x16x32_bf16 v[76:79], a[84:87], v[196:199], v[76:79]
  v_exp_f32 v191, v191
  v_mfma_f32_16x16x32_bf16 v[80:83], a[88:91], v[192:195], v[80:83]
  v_cvt_pk_bf16_f32 v204, v184, v185
  v_cvt_pk_bf16_f32 v205, v186, v187
  v_mfma_f32_16x16x32_bf16 v[88:91], a[88:91], v[196:199], v[88:91]
  v_cvt_pk_bf16_f32 v206, v188, v189
  v_cvt_pk_bf16_f32 v207, v190, v191
  v_mfma_f32_16x16x32_bf16 v[84:87], a[92:95], v[192:195], v[84:87]
  v_mfma_f32_16x16x32_bf16 v[92:95], a[92:95], v[196:199], v[92:95]
  s_waitcnt lgkmcnt(0)
  v_mfma_f32_16x16x32_bf16 v[160:163], a[96:99], a[0:3], v[240:243]
  s_add_u32 m0, s24, 131072
  v_mfma_f32_16x16x32_bf16 v[160:163], a[104:107], a[4:7], v[160:163]
  buffer_load_dwordx4 v7, s[16:19], s40 offen offset:0 nt lds
  v_mfma_f32_16x16x32_bf16 v[160:163], a[112:115], a[8:11], v[160:163]
  v_mfma_f32_16x16x32_bf16 v[160:163], a[120:123], a[12:15], v[160:163]
  v_mfma_f32_16x16x32_bf16 v[164:167], a[124:127], a[12:15], v[240:243]
  v_mfma_f32_16x16x32_bf16 v[164:167], a[116:119], a[8:11], v[164:167]
  buffer_load_dwordx4 v7, s[16:19], s40 offen offset:1024 nt lds
  v_mfma_f32_16x16x32_bf16 v[164:167], a[108:111], a[4:7], v[164:167]
  v_exp_f32 v160, v160
  v_mfma_f32_16x16x32_bf16 v[164:167], a[100:103], a[0:3], v[164:167]
  v_exp_f32 v161, v161
  v_mfma_f32_16x16x32_bf16 v[172:175], a[100:103], a[16:19], v[240:243]
  v_exp_f32 v162, v162
  v_mfma_f32_16x16x32_bf16 v[172:175], a[108:111], a[20:23], v[172:175]
  v_exp_f32 v163, v163
  v_mfma_f32_16x16x32_bf16 v[172:175], a[116:119], a[24:27], v[172:175]
  v_exp_f32 v164, v164
  v_mfma_f32_16x16x32_bf16 v[172:175], a[124:127], a[28:31], v[172:175]
  v_exp_f32 v165, v165
  v_mfma_f32_16x16x32_bf16 v[168:171], a[120:123], a[28:31], v[240:243]
  v_exp_f32 v166, v166
  v_mfma_f32_16x16x32_bf16 v[168:171], a[112:115], a[24:27], v[168:171]
  v_exp_f32 v167, v167
  v_mfma_f32_16x16x32_bf16 v[168:171], a[104:107], a[20:23], v[168:171]
  v_exp_f32 v172, v172
  v_mfma_f32_16x16x32_bf16 v[168:171], a[96:99], a[16:19], v[168:171]
  v_exp_f32 v173, v173
  v_mfma_f32_16x16x32_bf16 v[96:99], a[64:67], v[200:203], v[96:99]
  v_exp_f32 v174, v174
  v_mfma_f32_16x16x32_bf16 v[104:107], a[64:67], v[204:207], v[104:107]
  ds_read_b64_tr_b16 a[64:65], v4 offset:16384
  ds_read_b64_tr_b16 a[66:67], v4 offset:17408
  v_mfma_f32_16x16x32_bf16 v[100:103], a[68:71], v[200:203], v[100:103]
  v_exp_f32 v168, v168
  v_mfma_f32_16x16x32_bf16 v[108:111], a[68:71], v[204:207], v[108:111]
  buffer_load_dwordx4 v[220:223], v1, s[8:11], s30 offen offset:192 nt
  ds_read_b64_tr_b16 a[68:69], v4 offset:16392
  v_smfmac_f32_16x16x64_bf16 v[20:23], v[10:13], v[200:207], v0
  ds_read_b64_tr_b16 a[70:71], v4 offset:17416
  v_mfma_f32_16x16x32_bf16 v[112:115], a[72:75], v[200:203], v[112:115]
  v_exp_f32 v169, v169
  v_mfma_f32_16x16x32_bf16 v[120:123], a[72:75], v[204:207], v[120:123]
  ds_read_b64_tr_b16 a[72:73], v4 offset:16640
  ds_read_b64_tr_b16 a[74:75], v4 offset:17664
  v_mfma_f32_16x16x32_bf16 v[116:119], a[76:79], v[200:203], v[116:119]
  v_exp_f32 v170, v170
  v_mfma_f32_16x16x32_bf16 v[124:127], a[76:79], v[204:207], v[124:127]
  ds_read_b64_tr_b16 a[76:77], v4 offset:16648
  ds_read_b64_tr_b16 a[78:79], v4 offset:17672
  v_mfma_f32_16x16x32_bf16 v[128:131], a[80:83], v[200:203], v[128:131]
  v_exp_f32 v171, v171
  v_mfma_f32_16x16x32_bf16 v[136:139], a[80:83], v[204:207], v[136:139]
  v_exp_f32 v175, v175
  v_mfma_f32_16x16x32_bf16 v[132:135], a[84:87], v[200:203], v[132:135]
  ds_read_b64_tr_b16 a[80:81], v4 offset:16896
  v_cvt_pk_bf16_f32 v192, v160, v161
  v_mfma_f32_16x16x32_bf16 v[140:143], a[84:87], v[204:207], v[140:143]
  ds_read_b64_tr_b16 a[82:83], v4 offset:17920
  v_cvt_pk_bf16_f32 v193, v162, v163
  v_mfma_f32_16x16x32_bf16 v[144:147], a[88:91], v[200:203], v[144:147]
  ds_read_b64_tr_b16 a[84:85], v4 offset:16904
  v_cvt_pk_bf16_f32 v194, v164, v165
  v_mfma_f32_16x16x32_bf16 v[152:155], a[88:91], v[204:207], v[152:155]
  ds_read_b64_tr_b16 a[86:87], v4 offset:17928
  v_cvt_pk_bf16_f32 v195, v166, v167
  v_mfma_f32_16x16x32_bf16 v[148:151], a[92:95], v[200:203], v[148:151]
  ds_read_b64_tr_b16 a[88:89], v4 offset:17152
  v_cvt_pk_bf16_f32 v196, v168, v169
  v_mfma_f32_16x16x32_bf16 v[156:159], a[92:95], v[204:207], v[156:159]
  ds_read_b64_tr_b16 a[90:91], v4 offset:18176
  v_cvt_pk_bf16_f32 v197, v170, v171
  v_mfma_f32_16x16x32_bf16 v[176:179], a[96:99], a[32:35], v[240:243]
  s_add_u32 m0, s24, 81920
  ds_read_b64_tr_b16 a[92:93], v4 offset:17160
  v_cvt_pk_bf16_f32 v198, v172, v173
  v_mfma_f32_16x16x32_bf16 v[176:179], a[104:107], a[36:39], v[176:179]
L_t2:
  s_cbranch_vccnz L_back
  buffer_load_dwordx4 v6, s[12:15], s42 offen offset:0 nt lds
  v_cvt_pk_bf16_f32 v199, v174, v175
  v_mfma_f32_16x16x32_bf16 v[176:179], a[112:115], a[40:43], v[176:179]
  s_waitcnt vmcnt(10)
  ds_read_b64_tr_b16 a[94:95], v4 offset:18184
  v_lshlrev_b32 v8, 16, v208
  v_mfma_f32_16x16x32_bf16 v[176:179], a[120:123], a[44:47], v[176:179]
  v_and_b32 v9, s26, v208
  v_mul_f32 v8, s25, v8
  v_mfma_f32_16x16x32_bf16 v[180:183], a[124:127], a[44:47], v[240:243]
  v_mul_f32 v9, s25, v9
  v_cvt_pk_bf16_f32 v208, v8, v9
  v_mfma_f32_16x16x32_bf16 v[180:183], a[116:119], a[40:43], v[180:183]
  buffer_load_dwordx4 v6, s[12:15], s42 offen offset:1024 nt lds
  v_lshlrev_b32 v8, 16, v209
  v_mfma_f32_16x16x32_bf16 v[180:183], a[108:111], a[36:39], v[180:183]
  v_exp_f32 v176, v176
  v_mfma_f32_16x16x32_bf16 v[180:183], a[100:103], a[32:35], v[180:183]
  v_exp_f32 v177, v177
  v_mfma_f32_16x16x32_bf16 v[188:191], a[100:103], a[48:51], v[240:243]
  ds_read_b128 a[100:103], v2 offset:58368
  v_cvt_pk_bf16_f32 v200, v176, v177
  v_mfma_f32_16x16x32_bf16 v[188:191], a[108:111], a[52:55], v[188:191]
  ds_read_b128 a[108:111], v2 offset:58624
  v_and_b32 v9, s26, v209
  v_mfma_f32_16x16x32_bf16 v[188:191], a[116:119], a[56:59], v[188:191]
  ds_read_b128 a[116:119], v2 offset:58880
  v_mul_f32 v8, s25, v8
  v_mfma_f32_16x16x32_bf16 v[188:191], a[124:127], a[60:63], v[188:191]
  ds_read_b128 a[124:127], v2 offset:59136
  v_mul_f32 v9, s25, v9
  v_mfma_f32_16x16x32_bf16 v[184:187], a[120:123], a[60:63], v[240:243]
  ds_read_b128 a[120:123], v2 offset:58112
  v_cvt_pk_bf16_f32 v209, v8, v9
  v_mfma_f32_16x16x32_bf16 v[184:187], a[112:115], a[56:59], v[184:187]
  ds_read_b128 a[112:115], v2 offset:57856
  v_lshlrev_b32 v8, 16, v210
  v_mfma_f32_16x16x32_bf16 v[184:187], a[104:107], a[52:55], v[184:187]
  ds_read_b128 a[104:107], v2 offset:57600
  v_and_b32 v9, s26, v210
  v_mfma_f32_16x16x32_bf16 v[184:187], a[96:99], a[48:51], v[184:187]
  s_waitcnt lgkmcnt(5)
  ds_read_b128 a[96:99], v2 offset:57344
  v_mul_f32 v8, s25, v8
  v_mfma_f32_16x16x32_bf16 v[32:35], a[64:67], v[192:195], v[32:35]
  v_exp_f32 v178, v178
  v_mfma_f32_16x16x32_bf16 v[40:43], a[64:67], v[196:199], v[40:43]
  v_exp_f32 v179, v179
  v_mfma_f32_16x16x32_bf16 v[36:39], a[68:71], v[192:195], v[36:39]
  v_exp_f32 v180, v180
  v_mfma_f32_16x16x32_bf16 v[44:47], a[68:71], v[196:199], v[44:47]
  buffer_load_dwordx4 v[224:227], v1, s[8:11], s58 offen offset:0 nt
  v_cvt_pk_bf16_f32 v201, v178, v179
  v_smfmac_f32_16x16x64_bf16 v[14:17], v[10:13], v[192:199], v0
  v_mul_f32 v9, s25, v9
  v_mfma_f32_16x16x32_bf16 v[48:51], a[72:75], v[192:195], v[48:51]
  v_exp_f32 v181, v181
  v_mfma_f32_16x16x32_bf16 v[56:59], a[72:75], v[196:199], v[56:59]
  v_exp_f32 v182, v182
  v_mfma_f32_16x16x32_bf16 v[52:55], a[76:79], v[192:195], v[52:55]
  v_exp_f32 v183, v183
  v_mfma_f32_16x16x32_bf16 v[60:63], a[76:79], v[196:199], v[60:63]
  v_exp_f32 v184, v184
  v_mfma_f32_16x16x32_bf16 v[64:67], a[80:83], v[192:195], v[64:67]
  v_exp_f32 v185, v185
  v_mfma_f32_16x16x32_bf16 v[72:75], a[80:83], v[196:199], v[72:75]
  v_exp_f32 v186, v186
  v_mfma_f32_16x16x32_bf16 v[68:71], a[84:87], v[192:195], v[68:71]
  v_exp_f32 v187, v187
  v_mfma_f32_16x16x32_bf16 v[76:79], a[84:87], v[196:199], v[76:79]
  v_exp_f32 v188, v188
  v_mfma_f32_16x16x32_bf16 v[80:83], a[88:91], v[192:195], v[80:83]
  v_exp_f32 v189, v189
  v_mfma_f32_16x16x32_bf16 v[88:91], a[88:91], v[196:199], v[88:91]
  v_exp_f32 v190, v190
  v_mfma_f32_16x16x32_bf16 v[84:87], a[92:95], v[192:195], v[84:87]
  v_exp_f32 v191, v191
  v_mfma_f32_16x16x32_bf16 v[92:95], a[92:95], v[196:199], v[92:95]
  s_waitcnt lgkmcnt(0)
  v_cvt_pk_bf16_f32 v202, v180, v181
  v_cvt_pk_bf16_f32 v203, v182, v183
  v_mfma_f32_16x16x32_bf16 v[160:163], a[96:99], a[0:3], v[240:243]
  s_add_u32 m0, s24, 139264
  v_cvt_pk_bf16_f32 v204, v184, v185
  v_cvt_pk_bf16_f32 v205, v186, v187
  v_mfma_f32_16x16x32_bf16 v[160:163], a[104:107], a[4:7], v[160:163]
  buffer_load_dwordx4 v7, s[16:19], s41 offen offset:0 nt lds
  v_cvt_pk_bf16_f32 v206, v188, v189
  v_mfma_f32_16x16x32_bf16 v[160:163], a[112:115], a[8:11], v[160:163]
  v_cvt_pk_bf16_f32 v207, v190, v191
  v_cvt_pk_bf16_f32 v210, v8, v9
  v_mfma_f32_16x16x32_bf16 v[160:163], a[120:123], a[12:15], v[160:163]
  v_lshlrev_b32 v8, 16, v211
  v_and_b32 v9, s26, v211
  v_mfma_f32_16x16x32_bf16 v[164:167], a[124:127], a[12:15], v[240:243]
  v_mul_f32 v8, s25, v8
  v_mul_f32 v9, s25, v9
  v_mfma_f32_16x16x32_bf16 v[164:167], a[116:119], a[8:11], v[164:167]
  buffer_load_dwordx4 v7, s[16:19], s41 offen offset:1024 nt lds
  v_cvt_pk_bf16_f32 v211, v8, v9
  v_mfma_f32_16x16x32_bf16 v[164:167], a[108:111], a[4:7], v[164:167]
  v_exp_f32 v160, v160
  v_mfma_f32_16x16x32_bf16 v[164:167], a[100:103], a[0:3], v[164:167]
  v_exp_f32 v161, v161
  v_mfma_f32_16x16x32_bf16 v[172:175], a[100:103], a[16:19], v[240:243]
  v_exp_f32 v162, v162
  v_mfma_f32_16x16x32_bf16 v[172:175], a[108:111], a[20:23], v[172:175]
  v_exp_f32 v163, v163
  v_mfma_f32_16x16x32_bf16 v[172:175], a[116:119], a[24:27], v[172:175]
  v_exp_f32 v164, v164
  v_mfma_f32_16x16x32_bf16 v[172:175], a[124:127], a[28:31], v[172:175]
  v_exp_f32 v165, v165
  v_mfma_f32_16x16x32_bf16 v[168:171], a[120:123], a[28:31], v[240:243]
  v_exp_f32 v166, v166
  v_mfma_f32_16x16x32_bf16 v[168:171], a[112:115], a[24:27], v[168:171]
  v_exp_f32 v167, v167
  v_mfma_f32_16x16x32_bf16 v[168:171], a[104:107], a[20:23], v[168:171]
  s_waitcnt vmcnt(6)
  s_barrier
  v_cvt_pk_bf16_f32 v192, v160, v161
  v_mfma_f32_16x16x32_bf16 v[168:171], a[96:99], a[16:19], v[168:171]
  v_exp_f32 v172, v172
  v_mfma_f32_16x16x32_bf16 v[96:99], a[64:67], v[200:203], v[96:99]
  v_exp_f32 v173, v173
  v_mfma_f32_16x16x32_bf16 v[104:107], a[64:67], v[204:207], v[104:107]
  ds_read_b64_tr_b16 a[64:65], v4 offset:24576
  ds_read_b64_tr_b16 a[66:67], v4 offset:25600
  v_mfma_f32_16x16x32_bf16 v[100:103], a[68:71], v[200:203], v[100:103]
  v_exp_f32 v168, v168
  v_mfma_f32_16x16x32_bf16 v[108:111], a[68:71], v[204:207], v[108:111]
  buffer_load_dwordx4 v[228:231], v1, s[8:11], s58 offen offset:64 nt
  ds_read_b64_tr_b16 a[68:69], v4 offset:24584
  v_smfmac_f32_16x16x64_bf16 v[20:23], v[10:13], v[200:207], v0
  ds_read_b64_tr_b16 a[70:71], v4 offset:25608
  v_mfma_f32_16x16x32_bf16 v[112:115], a[72:75], v[200:203], v[112:115]
  v_exp_f32 v169, v169
  v_mfma_f32_16x16x32_bf16 v[120:123], a[72:75], v[204:207], v[120:123]
  ds_read_b64_tr_b16 a[72:73], v4 offset:24832
  ds_read_b64_tr_b16 a[74:75], v4 offset:25856
  v_mfma_f32_16x16x32_bf16 v[116:119], a[76:79], v[200:203], v[116:119]
  v_exp_f32 v170, v170
  v_mfma_f32_16x16x32_bf16 v[124:127], a[76:79], v[204:207], v[124:127]
  ds_read_b64_tr_b16 a[76:77], v4 offset:24840
  ds_read_b64_tr_b16 a[78:79], v4 offset:25864
  v_mfma_f32_16x16x32_bf16 v[128:131], a[80:83], v[200:203], v[128:131]
  v_exp_f32 v171, v171
  v_mfma_f32_16x16x32_bf16 v[136:139], a[80:83], v[204:207], v[136:139]
  v_exp_f32 v174, v174
  v_mfma_f32_16x16x32_bf16 v[132:135], a[84:87], v[200:203], v[132:135]
  v_exp_f32 v175, v175
  v_mfma_f32_16x16x32_bf16 v[140:143], a[84:87], v[204:207], v[140:143]
  ds_read_b64_tr_b16 a[80:81], v4 offset:25088
  v_cvt_pk_bf16_f32 v193, v162, v163
  v_mfma_f32_16x16x32_bf16 v[144:147], a[88:91], v[200:203], v[144:147]
  ds_read_b64_tr_b16 a[82:83], v4 offset:26112
  v_cvt_pk_bf16_f32 v194, v164, v165
  v_mfma_f32_16x16x32_bf16 v[152:155], a[88:91], v[204:207], v[152:155]
  ds_read_b64_tr_b16 a[84:85], v4 offset:25096
  v_cvt_pk_bf16_f32 v195, v166, v167
  v_mfma_f32_16x16x32_bf16 v[148:151], a[92:95], v[200:203], v[148:151]
  ds_read_b64_tr_b16 a[86:87], v4 offset:26120
  v_cvt_pk_bf16_f32 v196, v168, v169
  v_mfma_f32_16x16x32_bf16 v[156:159], a[92:95], v[204:207], v[156:159]
  ds_read_b64_tr_b16 a[88:89], v4 offset:25344
  v_cvt_pk_bf16_f32 v197, v170, v171
  v_mfma_f32_16x16x32_bf16 v[176:179], a[96:99], a[32:35], v[240:243]
  s_add_u32 m0, s24, 90112
  ds_read_b64_tr_b16 a[90:91], v4 offset:26368
  v_cvt_pk_bf16_f32 v198, v172, v173
  v_mfma_f32_16x16x32_bf16 v[176:179], a[104:107], a[36:39], v[176:179]
  buffer_load_dwordx4 v6, s[12:15], s43 offen offset:0 nt lds
  v_cvt_pk_bf16_f32 v199, v174, v175
  v_mfma_f32_16x16x32_bf16 v[176:179], a[112:115], a[40:43], v[176:179]
  ds_read_b64_tr_b16 a[92:93], v4 offset:25352
  ds_read_b64_tr_b16 a[94:95], v4 offset:26376
  v_mfma_f32_16x16x32_bf16 v[176:179], a[120:123], a[44:47], v[176:179]
  v_lshlrev_b32 v8, 16, v212
  v_and_b32 v9, s26, v212
  v_mfma_f32_16x16x32_bf16 v[180:183], a[124:127], a[44:47], v[240:243]
  v_mul_f32 v8, s25, v8
  v_mul_f32 v9, s25, v9
  v_mfma_f32_16x16x32_bf16 v[180:183], a[116:119], a[40:43], v[180:183]
  buffer_load_dwordx4 v6, s[12:15], s43 offen offset:1024 nt lds
  v_cvt_pk_bf16_f32 v212, v8, v9
  v_mfma_f32_16x16x32_bf16 v[180:183], a[108:111], a[36:39], v[180:183]
  v_exp_f32 v176, v176
  v_mfma_f32_16x16x32_bf16 v[180:183], a[100:103], a[32:35], v[180:183]
  v_exp_f32 v177, v177
  v_mfma_f32_16x16x32_bf16 v[188:191], a[100:103], a[48:51], v[240:243]
  ds_read_b128 a[100:103], v3 offset:1024
  v_cvt_pk_bf16_f32 v200, v176, v177
  v_mfma_f32_16x16x32_bf16 v[188:191], a[108:111], a[52:55], v[188:191]
  ds_read_b128 a[108:111], v3 offset:1280
  v_lshlrev_b32 v8, 16, v213
  v_mfma_f32_16x16x32_bf16 v[188:191], a[116:119], a[56:59], v[188:191]
  ds_read_b128 a[116:119], v3 offset:1536
  v_and_b32 v9, s26, v213
  v_mfma_f32_16x16x32_bf16 v[188:191], a[124:127], a[60:63], v[188:191]
  ds_read_b128 a[124:127], v3 offset:1792
  v_mul_f32 v8, s25, v8
  v_mfma_f32_16x16x32_bf16 v[184:187], a[120:123], a[60:63], v[240:243]
  ds_read_b128 a[120:123], v3 offset:768
  v_mul_f32 v9, s25, v9
  v_mfma_f32_16x16x32_bf16 v[184:187], a[112:115], a[56:59], v[184:187]
  ds_read_b128 a[112:115], v3 offset:512
  v_cvt_pk_bf16_f32 v213, v8, v9
  v_mfma_f32_16x16x32_bf16 v[184:187], a[104:107], a[52:55], v[184:187]
  ds_read_b128 a[104:107], v3 offset:256
  v_lshlrev_b32 v8, 16, v214
  v_mfma_f32_16x16x32_bf16 v[184:187], a[96:99], a[48:51], v[184:187]
  s_waitcnt lgkmcnt(5)
  ds_read_b128 a[96:99], v3 offset:0
  v_and_b32 v9, s26, v214
  v_mfma_f32_16x16x32_bf16 v[32:35], a[64:67], v[192:195], v[32:35]
  v_exp_f32 v178, v178
  v_mfma_f32_16x16x32_bf16 v[40:43], a[64:67], v[196:199], v[40:43]
  v_exp_f32 v179, v179
  v_mfma_f32_16x16x32_bf16 v[36:39], a[68:71], v[192:195], v[36:39]
  v_exp_f32 v180, v180
  v_mfma_f32_16x16x32_bf16 v[44:47], a[68:71], v[196:199], v[44:47]
  buffer_load_dwordx4 v[232:235], v1, s[8:11], s58 offen offset:128 nt
  v_cvt_pk_bf16_f32 v201, v178, v179
  v_smfmac_f32_16x16x64_bf16 v[14:17], v[10:13], v[192:199], v0
  v_mul_f32 v8, s25, v8
  v_mfma_f32_16x16x32_bf16 v[48:51], a[72:75], v[192:195], v[48:51]
  v_exp_f32 v181, v181
  v_mfma_f32_16x16x32_bf16 v[56:59], a[72:75], v[196:199], v[56:59]
  v_exp_f32 v182, v182
  v_mfma_f32_16x16x32_bf16 v[52:55], a[76:79], v[192:195], v[52:55]
  v_exp_f32 v183, v183
  v_mfma_f32_16x16x32_bf16 v[60:63], a[76:79], v[196:199], v[60:63]
  v_exp_f32 v184, v184
  v_mfma_f32_16x16x32_bf16 v[64:67], a[80:83], v[192:195], v[64:67]
  v_exp_f32 v185, v185
  v_mfma_f32_16x16x32_bf16 v[72:75], a[80:83], v[196:199], v[72:75]
  v_exp_f32 v186, v186
  v_mfma_f32_16x16x32_bf16 v[68:71], a[84:87], v[192:195], v[68:71]
  v_exp_f32 v187, v187
  v_mfma_f32_16x16x32_bf16 v[76:79], a[84:87], v[196:199], v[76:79]
  v_exp_f32 v188, v188
  v_mfma_f32_16x16x32_bf16 v[80:83], a[88:91], v[192:195], v[80:83]
  v_exp_f32 v189, v189
  v_mfma_f32_16x16x32_bf16 v[88:91], a[88:91], v[196:199], v[88:91]
  v_exp_f32 v190, v190
  v_mfma_f32_16x16x32_bf16 v[84:87], a[92:95], v[192:195], v[84:87]
  v_exp_f32 v191, v191
  v_mfma_f32_16x16x32_bf16 v[92:95], a[92:95], v[196:199], v[92:95]
  s_waitcnt lgkmcnt(0)
  v_cvt_pk_bf16_f32 v202, v180, v181
  v_cvt_pk_bf16_f32 v203, v182, v183
  v_mfma_f32_16x16x32_bf16 v[160:163], a[96:99], a[0:3], v[240:243]
  s_add_u32 m0, s24, 147456
  v_cvt_pk_bf16_f32 v204, v184, v185
  v_cvt_pk_bf16_f32 v205, v186, v187
  v_mfma_f32_16x16x32_bf16 v[160:163], a[104:107], a[4:7], v[160:163]
  buffer_load_dwordx4 v7, s[16:19], s42 offen offset:0 nt lds
  v_cvt_pk_bf16_f32 v206, v188, v189
  v_mfma_f32_16x16x32_bf16 v[160:163], a[112:115], a[8:11], v[160:163]
  v_cvt_pk_bf16_f32 v207, v190, v191
  v_mul_f32 v9, s25, v9
  v_mfma_f32_16x16x32_bf16 v[160:163], a[120:123], a[12:15], v[160:163]
  v_cvt_pk_bf16_f32 v214, v8, v9
  v_lshlrev_b32 v8, 16, v215
  v_mfma_f32_16x16x32_bf16 v[164:167], a[124:127], a[12:15], v[240:243]
  v_and_b32 v9, s26, v215
  v_mul_f32 v8, s25, v8
  v_mfma_f32_16x16x32_bf16 v[164:167], a[116:119], a[8:11], v[164:167]
  buffer_load_dwordx4 v7, s[16:19], s42 offen offset:1024 nt lds
  v_mul_f32 v9, s25, v9
  v_mfma_f32_16x16x32_bf16 v[164:167], a[108:111], a[4:7], v[164:167]
  v_exp_f32 v160, v160
  v_mfma_f32_16x16x32_bf16 v[164:167], a[100:103], a[0:3], v[164:167]
  v_exp_f32 v161, v161
  v_mfma_f32_16x16x32_bf16 v[172:175], a[100:103], a[16:19], v[240:243]
  v_exp_f32 v162, v162
  v_mfma_f32_16x16x32_bf16 v[172:175], a[108:111], a[20:23], v[172:175]
  v_exp_f32 v163, v163
  v_mfma_f32_16x16x32_bf16 v[172:175], a[116:119], a[24:27], v[172:175]
  v_exp_f32 v164, v164
  v_mfma_f32_16x16x32_bf16 v[172:175], a[124:127], a[28:31], v[172:175]
  v_exp_f32 v165, v165
  v_mfma_f32_16x16x32_bf16 v[168:171], a[120:123], a[28:31], v[240:243]
  v_exp_f32 v166, v166
  v_mfma_f32_16x16x32_bf16 v[168:171], a[112:115], a[24:27], v[168:171]
  v_exp_f32 v167, v167
  v_mfma_f32_16x16x32_bf16 v[168:171], a[104:107], a[20:23], v[168:171]
  v_exp_f32 v172, v172
  v_mfma_f32_16x16x32_bf16 v[168:171], a[96:99], a[16:19], v[168:171]
  v_exp_f32 v173, v173
  v_mfma_f32_16x16x32_bf16 v[96:99], a[64:67], v[200:203], v[96:99]
  v_exp_f32 v174, v174
  v_mfma_f32_16x16x32_bf16 v[104:107], a[64:67], v[204:207], v[104:107]
  ds_read_b64_tr_b16 a[64:65], v4 offset:32768
  ds_read_b64_tr_b16 a[66:67], v4 offset:33792
  v_mfma_f32_16x16x32_bf16 v[100:103], a[68:71], v[200:203], v[100:103]
  v_exp_f32 v168, v168
  v_mfma_f32_16x16x32_bf16 v[108:111], a[68:71], v[204:207], v[108:111]
  buffer_load_dwordx4 v[236:239], v1, s[8:11], s58 offen offset:192 nt
  ds_read_b64_tr_b16 a[68:69], v4 offset:32776
  v_smfmac_f32_16x16x64_bf16 v[20:23], v[10:13], v[200:207], v0
  ds_read_b64_tr_b16 a[70:71], v4 offset:33800
  v_mfma_f32_16x16x32_bf16 v[112:115], a[72:75], v[200:203], v[112:115]
  v_exp_f32 v169, v169
  v_mfma_f32_16x16x32_bf16 v[120:123], a[72:75], v[204:207], v[120:123]
  ds_read_b64_tr_b16 a[72:73], v4 offset:33024
  ds_read_b64_tr_b16 a[74:75], v4 offset:34048
  v_mfma_f32_16x16x32_bf16 v[116:119], a[76:79], v[200:203], v[116:119]
  v_exp_f32 v170, v170
  v_mfma_f32_16x16x32_bf16 v[124:127], a[76:79], v[204:207], v[124:127]
  ds_read_b64_tr_b16 a[76:77], v4 offset:33032
  ds_read_b64_tr_b16 a[78:79], v4 offset:34056
  v_mfma_f32_16x16x32_bf16 v[128:131], a[80:83], v[200:203], v[128:131]
  v_exp_f32 v171, v171
  v_mfma_f32_16x16x32_bf16 v[136:139], a[80:83], v[204:207], v[136:139]
  v_exp_f32 v175, v175
  v_mfma_f32_16x16x32_bf16 v[132:135], a[84:87], v[200:203], v[132:135]
  ds_read_b64_tr_b16 a[80:81], v4 offset:33280
  v_cvt_pk_bf16_f32 v192, v160, v161
  v_mfma_f32_16x16x32_bf16 v[140:143], a[84:87], v[204:207], v[140:143]
  ds_read_b64_tr_b16 a[82:83], v4 offset:34304
  v_cvt_pk_bf16_f32 v193, v162, v163
  v_mfma_f32_16x16x32_bf16 v[144:147], a[88:91], v[200:203], v[144:147]
  ds_read_b64_tr_b16 a[84:85], v4 offset:33288
  v_cvt_pk_bf16_f32 v194, v164, v165
  v_mfma_f32_16x16x32_bf16 v[152:155], a[88:91], v[204:207], v[152:155]
  ds_read_b64_tr_b16 a[86:87], v4 offset:34312
  v_cvt_pk_bf16_f32 v195, v166, v167
  v_mfma_f32_16x16x32_bf16 v[148:151], a[92:95], v[200:203], v[148:151]
  ds_read_b64_tr_b16 a[88:89], v4 offset:33536
  v_cvt_pk_bf16_f32 v196, v168, v169
  v_mfma_f32_16x16x32_bf16 v[156:159], a[92:95], v[204:207], v[156:159]
  ds_read_b64_tr_b16 a[90:91], v4 offset:34560
  v_cvt_pk_bf16_f32 v197, v170, v171
  v_mfma_f32_16x16x32_bf16 v[176:179], a[96:99], a[32:35], v[240:243]
  s_add_u32 m0, s24, 155648
  ds_read_b64_tr_b16 a[92:93], v4 offset:33544
  v_cvt_pk_bf16_f32 v198, v172, v173
  v_mfma_f32_16x16x32_bf16 v[176:179], a[104:107], a[36:39], v[176:179]
  buffer_load_dwordx4 v7, s[16:19], s43 offen offset:0 nt lds
  v_cvt_pk_bf16_f32 v199, v174, v175
  v_mfma_f32_16x16x32_bf16 v[176:179], a[112:115], a[40:43], v[176:179]
  ds_read_b64_tr_b16 a[94:95], v4 offset:34568
  v_cvt_pk_bf16_f32 v215, v8, v9
  v_mfma_f32_16x16x32_bf16 v[176:179], a[120:123], a[44:47], v[176:179]
  v_lshlrev_b32 v8, 16, v216
  v_and_b32 v9, s26, v216
  v_mfma_f32_16x16x32_bf16 v[180:183], a[124:127], a[44:47], v[240:243]
  v_mul_f32 v8, s25, v8
  v_mul_f32 v9, s25, v9
  v_mfma_f32_16x16x32_bf16 v[180:183], a[116:119], a[40:43], v[180:183]
  buffer_load_dwordx4 v7, s[16:19], s43 offen offset:1024 nt lds
  v_cvt_pk_bf16_f32 v216, v8, v9
  v_mfma_f32_16x16x32_bf16 v[180:183], a[108:111], a[36:39], v[180:183]
  v_exp_f32 v176, v176
  v_mfma_f32_16x16x32_bf16 v[180:183], a[100:103], a[32:35], v[180:183]
  v_exp_f32 v177, v177
  v_mfma_f32_16x16x32_bf16 v[188:191], a[100:103], a[48:51], v[240:243]
  ds_read_b128 a[100:103], v3 offset:9216
  v_cvt_pk_bf16_f32 v200, v176, v177
  v_mfma_f32_16x16x32_bf16 v[188:191], a[108:111], a[52:55], v[188:191]
  ds_read_b128 a[108:111], v3 offset:9472
  v_lshlrev_b32 v8, 16, v217
  v_mfma_f32_16x16x32_bf16 v[188:191], a[116:119], a[56:59], v[188:191]
  ds_read_b128 a[116:119], v3 offset:9728
  v_and_b32 v9, s26, v217
  v_mfma_f32_16x16x32_bf16 v[188:191], a[124:127], a[60:63], v[188:191]
  ds_read_b128 a[124:127], v3 offset:9984
  v_mul_f32 v8, s25, v8
  v_mfma_f32_16x16x32_bf16 v[184:187], a[120:123], a[60:63], v[240:243]
  ds_read_b128 a[120:123], v3 offset:8960
  v_mul_f32 v9, s25, v9
  v_mfma_f32_16x16x32_bf16 v[184:187], a[112:115], a[56:59], v[184:187]
  ds_read_b128 a[112:115], v3 offset:8704
  v_cvt_pk_bf16_f32 v217, v8, v9
  v_mfma_f32_16x16x32_bf16 v[184:187], a[104:107], a[52:55], v[184:187]
  ds_read_b128 a[104:107], v3 offset:8448
  v_lshlrev_b32 v8, 16, v218
  v_mfma_f32_16x16x32_bf16 v[184:187], a[96:99], a[48:51], v[184:187]
  s_waitcnt lgkmcnt(5)
  ds_read_b128 a[96:99], v3 offset:8192
  v_and_b32 v9, s26, v218
  v_mfma_f32_16x16x32_bf16 v[32:35], a[64:67], v[192:195], v[32:35]
  v_exp_f32 v178, v178
  v_mfma_f32_16x16x32_bf16 v[40:43], a[64:67], v[196:199], v[40:43]
  v_exp_f32 v179, v179
  v_mfma_f32_16x16x32_bf16 v[36:39], a[68:71], v[192:195], v[36:39]
  v_exp_f32 v180, v180
  v_mfma_f32_16x16x32_bf16 v[44:47], a[68:71], v[196:199], v[44:47]
  v_exp_f32 v181, v181
  v_smfmac_f32_16x16x64_bf16 v[14:17], v[10:13], v[192:199], v0
  v_cvt_pk_bf16_f32 v201, v178, v179
  v_mfma_f32_16x16x32_bf16 v[48:51], a[72:75], v[192:195], v[48:51]
  v_exp_f32 v182, v182
  v_mfma_f32_16x16x32_bf16 v[56:59], a[72:75], v[196:199], v[56:59]
  v_exp_f32 v183, v183
  v_mfma_f32_16x16x32_bf16 v[52:55], a[76:79], v[192:195], v[52:55]
  v_exp_f32 v184, v184
  v_mfma_f32_16x16x32_bf16 v[60:63], a[76:79], v[196:199], v[60:63]
  v_exp_f32 v185, v185
  v_mfma_f32_16x16x32_bf16 v[64:67], a[80:83], v[192:195], v[64:67]
  v_exp_f32 v186, v186
  v_mfma_f32_16x16x32_bf16 v[72:75], a[80:83], v[196:199], v[72:75]
  v_exp_f32 v187, v187
  v_mfma_f32_16x16x32_bf16 v[68:71], a[84:87], v[192:195], v[68:71]
  v_exp_f32 v188, v188
  v_mfma_f32_16x16x32_bf16 v[76:79], a[84:87], v[196:199], v[76:79]
  v_exp_f32 v189, v189
  v_mfma_f32_16x16x32_bf16 v[80:83], a[88:91], v[192:195], v[80:83]
  v_exp_f32 v190, v190
  v_mfma_f32_16x16x32_bf16 v[88:91], a[88:91], v[196:199], v[88:91]
  v_exp_f32 v191, v191
  v_mfma_f32_16x16x32_bf16 v[84:87], a[92:95], v[192:195], v[84:87]
  v_cvt_pk_bf16_f32 v202, v180, v181
  v_cvt_pk_bf16_f32 v203, v182, v183
  v_mfma_f32_16x16x32_bf16 v[92:95], a[92:95], v[196:199], v[92:95]
  s_waitcnt lgkmcnt(0)
  v_cvt_pk_bf16_f32 v204, v184, v185
  v_cvt_pk_bf16_f32 v205, v186, v187
  v_mfma_f32_16x16x32_bf16 v[160:163], a[96:99], a[0:3], v[240:243]
  v_cvt_pk_bf16_f32 v206, v188, v189
  v_cvt_pk_bf16_f32 v207, v190, v191
  v_mfma_f32_16x16x32_bf16 v[160:163], a[104:107], a[4:7], v[160:163]
  v_mul_f32 v8, s25, v8
  v_mul_f32 v9, s25, v9
  v_mfma_f32_16x16x32_bf16 v[160:163], a[112:115], a[8:11], v[160:163]
  v_cvt_pk_bf16_f32 v218, v8, v9
  v_lshlrev_b32 v8, 16, v219
  v_mfma_f32_16x16x32_bf16 v[160:163], a[120:123], a[12:15], v[160:163]
  v_and_b32 v9, s26, v219
  v_mul_f32 v8, s25, v8
  v_mfma_f32_16x16x32_bf16 v[164:167], a[124:127], a[12:15], v[240:243]
  v_mul_f32 v9, s25, v9
  v_cvt_pk_bf16_f32 v219, v8, v9
  v_mfma_f32_16x16x32_bf16 v[164:167], a[116:119], a[8:11], v[164:167]
  s_waitcnt vmcnt(14)
  v_lshlrev_b32 v8, 16, v220
  v_and_b32 v9, s26, v220
  v_mfma_f32_16x16x32_bf16 v[164:167], a[108:111], a[4:7], v[164:167]
  v_exp_f32 v160, v160
  v_mfma_f32_16x16x32_bf16 v[164:167], a[100:103], a[0:3], v[164:167]
  v_exp_f32 v161, v161
  v_mfma_f32_16x16x32_bf16 v[172:175], a[100:103], a[16:19], v[240:243]
  v_exp_f32 v162, v162
  v_mfma_f32_16x16x32_bf16 v[172:175], a[108:111], a[20:23], v[172:175]
  v_exp_f32 v163, v163
  v_mfma_f32_16x16x32_bf16 v[172:175], a[116:119], a[24:27], v[172:175]
  v_exp_f32 v164, v164
  v_mfma_f32_16x16x32_bf16 v[172:175], a[124:127], a[28:31], v[172:175]
  v_exp_f32 v165, v165
  v_mfma_f32_16x16x32_bf16 v[168:171], a[120:123], a[28:31], v[240:243]
  v_exp_f32 v166, v166
  v_mfma_f32_16x16x32_bf16 v[168:171], a[112:115], a[24:27], v[168:171]
  v_exp_f32 v167, v167
  v_mfma_f32_16x16x32_bf16 v[168:171], a[104:107], a[20:23], v[168:171]
  s_waitcnt vmcnt(3)
  s_barrier
  v_cvt_pk_bf16_f32 v192, v160, v161
  v_mfma_f32_16x16x32_bf16 v[168:171], a[96:99], a[16:19], v[168:171]
  v_exp_f32 v172, v172
  v_mfma_f32_16x16x32_bf16 v[96:99], a[64:67], v[200:203], v[96:99]
  v_exp_f32 v173, v173
  v_mfma_f32_16x16x32_bf16 v[104:107], a[64:67], v[204:207], v[104:107]
  ds_read_b64_tr_b16 a[64:65], v4 offset:40960
  ds_read_b64_tr_b16 a[66:67], v4 offset:41984
  v_mfma_f32_16x16x32_bf16 v[100:103], a[68:71], v[200:203], v[100:103]
  v_exp_f32 v168, v168
  v_mfma_f32_16x16x32_bf16 v[108:111], a[68:71], v[204:207], v[108:111]
  ds_read_b64_tr_b16 a[68:69], v4 offset:40968
  ds_read_b64_tr_b16 a[70:71], v4 offset:41992
  v_smfmac_f32_16x16x64_bf16 v[20:23], v[10:13], v[200:207], v0
  v_cvt_pk_bf16_f32 v193, v162, v163
  v_mfma_f32_16x16x32_bf16 v[112:115], a[72:75], v[200:203], v[112:115]
  v_exp_f32 v169, v169
  v_mfma_f32_16x16x32_bf16 v[120:123], a[72:75], v[204:207], v[120:123]
  ds_read_b64_tr_b16 a[72:73], v4 offset:41216
  ds_read_b64_tr_b16 a[74:75], v4 offset:42240
  v_mfma_f32_16x16x32_bf16 v[116:119], a[76:79], v[200:203], v[116:119]
  v_exp_f32 v170, v170
  v_mfma_f32_16x16x32_bf16 v[124:127], a[76:79], v[204:207], v[124:127]
  ds_read_b64_tr_b16 a[76:77], v4 offset:41224
  ds_read_b64_tr_b16 a[78:79], v4 offset:42248
  v_mfma_f32_16x16x32_bf16 v[128:131], a[80:83], v[200:203], v[128:131]
  v_exp_f32 v171, v171
  v_mfma_f32_16x16x32_bf16 v[136:139], a[80:83], v[204:207], v[136:139]
  v_exp_f32 v174, v174
  v_mfma_f32_16x16x32_bf16 v[132:135], a[84:87], v[200:203], v[132:135]
  v_exp_f32 v175, v175
  v_mfma_f32_16x16x32_bf16 v[140:143], a[84:87], v[204:207], v[140:143]
  ds_read_b64_tr_b16 a[80:81], v4 offset:41472
  v_cvt_pk_bf16_f32 v194, v164, v165
  v_mfma_f32_16x16x32_bf16 v[144:147], a[88:91], v[200:203], v[144:147]
  ds_read_b64_tr_b16 a[82:83], v4 offset:42496
  v_cvt_pk_bf16_f32 v195, v166, v167
  v_mfma_f32_16x16x32_bf16 v[152:155], a[88:91], v[204:207], v[152:155]
  ds_read_b64_tr_b16 a[84:85], v4 offset:41480
  v_cvt_pk_bf16_f32 v196, v168, v169
  v_mfma_f32_16x16x32_bf16 v[148:151], a[92:95], v[200:203], v[148:151]
  ds_read_b64_tr_b16 a[86:87], v4 offset:42504
  v_cvt_pk_bf16_f32 v197, v170, v171
  v_mfma_f32_16x16x32_bf16 v[156:159], a[92:95], v[204:207], v[156:159]
  ds_read_b64_tr_b16 a[88:89], v4 offset:41728
  v_cvt_pk_bf16_f32 v198, v172, v173
  v_mfma_f32_16x16x32_bf16 v[176:179], a[96:99], a[32:35], v[240:243]
  ds_read_b64_tr_b16 a[90:91], v4 offset:42752
  v_cvt_pk_bf16_f32 v199, v174, v175
  v_mfma_f32_16x16x32_bf16 v[176:179], a[104:107], a[36:39], v[176:179]
  ds_read_b64_tr_b16 a[92:93], v4 offset:41736
  ds_read_b64_tr_b16 a[94:95], v4 offset:42760
  v_mfma_f32_16x16x32_bf16 v[176:179], a[112:115], a[40:43], v[176:179]
  v_mul_f32 v8, s25, v8
  v_mul_f32 v9, s25, v9
  v_mfma_f32_16x16x32_bf16 v[176:179], a[120:123], a[44:47], v[176:179]
  v_cvt_pk_bf16_f32 v220, v8, v9
  v_lshlrev_b32 v8, 16, v221
  v_mfma_f32_16x16x32_bf16 v[180:183], a[124:127], a[44:47], v[240:243]
  v_and_b32 v9, s26, v221
  v_mul_f32 v8, s25, v8
  v_mfma_f32_16x16x32_bf16 v[180:183], a[116:119], a[40:43], v[180:183]
  v_mul_f32 v9, s25, v9
  v_cvt_pk_bf16_f32 v221, v8, v9
  v_mfma_f32_16x16x32_bf16 v[180:183], a[108:111], a[36:39], v[180:183]
  v_exp_f32 v176, v176
  v_mfma_f32_16x16x32_bf16 v[180:183], a[100:103], a[32:35], v[180:183]
  v_exp_f32 v177, v177
  v_mfma_f32_16x16x32_bf16 v[188:191], a[100:103], a[48:51], v[240:243]
  ds_read_b128 a[100:103], v3 offset:17408
  v_cvt_pk_bf16_f32 v200, v176, v177
  v_mfma_f32_16x16x32_bf16 v[188:191], a[108:111], a[52:55], v[188:191]
  ds_read_b128 a[108:111], v3 offset:17664
  v_lshlrev_b32 v8, 16, v222
  v_mfma_f32_16x16x32_bf16 v[188:191], a[116:119], a[56:59], v[188:191]
  ds_read_b128 a[116:119], v3 offset:17920
  v_and_b32 v9, s26, v222
  v_mfma_f32_16x16x32_bf16 v[188:191], a[124:127], a[60:63], v[188:191]
  ds_read_b128 a[124:127], v3 offset:18176
  v_mul_f32 v8, s25, v8
  v_mfma_f32_16x16x32_bf16 v[184:187], a[120:123], a[60:63], v[240:243]
  ds_read_b128 a[120:123], v3 offset:17152
  v_mul_f32 v9, s25, v9
  v_mfma_f32_16x16x32_bf16 v[184:187], a[112:115], a[56:59], v[184:187]
  ds_read_b128 a[112:115], v3 offset:16896
  v_cvt_pk_bf16_f32 v222, v8, v9
  v_mfma_f32_16x16x32_bf16 v[184:187], a[104:107], a[52:55], v[184:187]
  ds_read_b128 a[104:107], v3 offset:16640
  v_lshlrev_b32 v8, 16, v223
  v_mfma_f32_16x16x32_bf16 v[184:187], a[96:99], a[48:51], v[184:187]
  s_waitcnt lgkmcnt(5)
  ds_read_b128 a[96:99], v3 offset:16384
  v_and_b32 v9, s26, v223
  v_mfma_f32_16x16x32_bf16 v[32:35], a[64:67], v[192:195], v[32:35]
  v_exp_f32 v178, v178
  v_mfma_f32_16x16x32_bf16 v[40:43], a[64:67], v[196:199], v[40:43]
  v_exp_f32 v179, v179
  v_mfma_f32_16x16x32_bf16 v[36:39], a[68:71], v[192:195], v[36:39]
  v_exp_f32 v180, v180
  v_mfma_f32_16x16x32_bf16 v[44:47], a[68:71], v[196:199], v[44:47]
  v_exp_f32 v181, v181
  v_smfmac_f32_16x16x64_bf16 v[14:17], v[10:13], v[192:199], v0
  v_cvt_pk_bf16_f32 v201, v178, v179
  v_mfma_f32_16x16x32_bf16 v[48:51], a[72:75], v[192:195], v[48:51]
  v_exp_f32 v182, v182
  v_mfma_f32_16x16x32_bf16 v[56:59], a[72:75], v[196:199], v[56:59]
  v_exp_f32 v183, v183
  v_mfma_f32_16x16x32_bf16 v[52:55], a[76:79], v[192:195], v[52:55]
  v_exp_f32 v184, v184
  v_mfma_f32_16x16x32_bf16 v[60:63], a[76:79], v[196:199], v[60:63]
  v_exp_f32 v185, v185
  v_mfma_f32_16x16x32_bf16 v[64:67], a[80:83], v[192:195], v[64:67]
  v_exp_f32 v186, v186
  v_mfma_f32_16x16x32_bf16 v[72:75], a[80:83], v[196:199], v[72:75]
  v_exp_f32 v187, v187
  v_mfma_f32_16x16x32_bf16 v[68:71], a[84:87], v[192:195], v[68:71]
  v_exp_f32 v188, v188
  v_mfma_f32_16x16x32_bf16 v[76:79], a[84:87], v[196:199], v[76:79]
  v_exp_f32 v189, v189
  v_mfma_f32_16x16x32_bf16 v[80:83], a[88:91], v[192:195], v[80:83]
  v_exp_f32 v190, v190
  v_mfma_f32_16x16x32_bf16 v[88:91], a[88:91], v[196:199], v[88:91]
  v_exp_f32 v191, v191
  v_mfma_f32_16x16x32_bf16 v[84:87], a[92:95], v[192:195], v[84:87]
  v_cvt_pk_bf16_f32 v202, v180, v181
  v_cvt_pk_bf16_f32 v203, v182, v183
  v_mfma_f32_16x16x32_bf16 v[92:95], a[92:95], v[196:199], v[92:95]
  s_waitcnt lgkmcnt(0)
  v_cvt_pk_bf16_f32 v204, v184, v185
  v_cvt_pk_bf16_f32 v205, v186, v187
  v_mfma_f32_16x16x32_bf16 v[160:163], a[96:99], a[0:3], v[240:243]
  v_cvt_pk_bf16_f32 v206, v188, v189
  v_cvt_pk_bf16_f32 v207, v190, v191
  v_mfma_f32_16x16x32_bf16 v[160:163], a[104:107], a[4:7], v[160:163]
  v_mul_f32 v8, s25, v8
  v_mul_f32 v9, s25, v9
  v_mfma_f32_16x16x32_bf16 v[160:163], a[112:115], a[8:11], v[160:163]
  v_cvt_pk_bf16_f32 v223, v8, v9
  v_lshlrev_b32 v8, 16, v224
  v_mfma_f32_16x16x32_bf16 v[160:163], a[120:123], a[12:15], v[160:163]
  v_and_b32 v9, s26, v224
  v_mul_f32 v8, s25, v8
  v_mfma_f32_16x16x32_bf16 v[164:167], a[124:127], a[12:15], v[240:243]
  v_mul_f32 v9, s25, v9
  v_cvt_pk_bf16_f32 v224, v8, v9
  v_mfma_f32_16x16x32_bf16 v[164:167], a[116:119], a[8:11], v[164:167]
  v_lshlrev_b32 v8, 16, v225
  v_and_b32 v9, s26, v225
  v_mfma_f32_16x16x32_bf16 v[164:167], a[108:111], a[4:7], v[164:167]
  v_exp_f32 v160, v160
  v_mfma_f32_16x16x32_bf16 v[164:167], a[100:103], a[0:3], v[164:167]
L_t3:
  s_cbranch_vccnz L_back
  v_exp_f32 v161, v161
  v_mfma_f32_16x16x32_bf16 v[172:175], a[100:103], a[16:19], v[240:243]
  v_exp_f32 v162, v162
  v_mfma_f32_16x16x32_bf16 v[172:175], a[108:111], a[20:23], v[172:175]
  v_exp_f32 v163, v163
  v_mfma_f32_16x16x32_bf16 v[172:175], a[116:119], a[24:27], v[172:175]
  v_exp_f32 v164, v164
  v_mfma_f32_16x16x32_bf16 v[172:175], a[124:127], a[28:31], v[172:175]
  v_exp_f32 v165, v165
  v_mfma_f32_16x16x32_bf16 v[168:171], a[120:123], a[28:31], v[240:243]
  v_exp_f32 v166, v166
  v_mfma_f32_16x16x32_bf16 v[168:171], a[112:115], a[24:27], v[168:171]
  v_exp_f32 v167, v167
  v_mfma_f32_16x16x32_bf16 v[168:171], a[104:107], a[20:23], v[168:171]
  v_exp_f32 v172, v172
  v_mfma_f32_16x16x32_bf16 v[168:171], a[96:99], a[16:19], v[168:171]
  v_exp_f32 v173, v173
  v_mfma_f32_16x16x32_bf16 v[96:99], a[64:67], v[200:203], v[96:99]
  v_exp_f32 v174, v174
  v_mfma_f32_16x16x32_bf16 v[104:107], a[64:67], v[204:207], v[104:107]
  ds_read_b64_tr_b16 a[64:65], v4 offset:49152
  ds_read_b64_tr_b16 a[66:67], v4 offset:50176
  v_mfma_f32_16x16x32_bf16 v[100:103], a[68:71], v[200:203], v[100:103]
  v_exp_f32 v168, v168
  v_mfma_f32_16x16x32_bf16 v[108:111], a[68:71], v[204:207], v[108:111]
  ds_read_b64_tr_b16 a[68:69], v4 offset:49160
  ds_read_b64_tr_b16 a[70:71], v4 offset:50184
  v_smfmac_f32_16x16x64_bf16 v[20:23], v[10:13], v[200:207], v0
  v_cvt_pk_bf16_f32 v192, v160, v161
  v_mfma_f32_16x16x32_bf16 v[112:115], a[72:75], v[200:203], v[112:115]
  v_exp_f32 v169, v169
  v_mfma_f32_16x16x32_bf16 v[120:123], a[72:75], v[204:207], v[120:123]
  ds_read_b64_tr_b16 a[72:73], v4 offset:49408
  ds_read_b64_tr_b16 a[74:75], v4 offset:50432
  v_mfma_f32_16x16x32_bf16 v[116:119], a[76:79], v[200:203], v[116:119]
  v_exp_f32 v170, v170
  v_mfma_f32_16x16x32_bf16 v[124:127], a[76:79], v[204:207], v[124:127]
  ds_read_b64_tr_b16 a[76:77], v4 offset:49416
  ds_read_b64_tr_b16 a[78:79], v4 offset:50440
  v_mfma_f32_16x16x32_bf16 v[128:131], a[80:83], v[200:203], v[128:131]
  v_exp_f32 v171, v171
  v_mfma_f32_16x16x32_bf16 v[136:139], a[80:83], v[204:207], v[136:139]
  v_exp_f32 v175, v175
  v_mfma_f32_16x16x32_bf16 v[132:135], a[84:87], v[200:203], v[132:135]
  ds_read_b64_tr_b16 a[80:81], v4 offset:49664
  v_cvt_pk_bf16_f32 v193, v162, v163
  v_mfma_f32_16x16x32_bf16 v[140:143], a[84:87], v[204:207], v[140:143]
  ds_read_b64_tr_b16 a[82:83], v4 offset:50688
  v_cvt_pk_bf16_f32 v194, v164, v165
  v_mfma_f32_16x16x32_bf16 v[144:147], a[88:91], v[200:203], v[144:147]
  ds_read_b64_tr_b16 a[84:85], v4 offset:49672
  v_cvt_pk_bf16_f32 v195, v166, v167
  v_mfma_f32_16x16x32_bf16 v[152:155], a[88:91], v[204:207], v[152:155]
  ds_read_b64_tr_b16 a[86:87], v4 offset:50696
  v_cvt_pk_bf16_f32 v196, v168, v169
  v_mfma_f32_16x16x32_bf16 v[148:151], a[92:95], v[200:203], v[148:151]
  ds_read_b64_tr_b16 a[88:89], v4 offset:49920
  v_cvt_pk_bf16_f32 v197, v170, v171
  v_mfma_f32_16x16x32_bf16 v[156:159], a[92:95], v[204:207], v[156:159]
  ds_read_b64_tr_b16 a[90:91], v4 offset:50944
  v_cvt_pk_bf16_f32 v198, v172, v173
  v_mfma_f32_16x16x32_bf16 v[176:179], a[96:99], a[32:35], v[240:243]
  ds_read_b64_tr_b16 a[92:93], v4 offset:49928
  v_cvt_pk_bf16_f32 v199, v174, v175
  v_mfma_f32_16x16x32_bf16 v[176:179], a[104:107], a[36:39], v[176:179]
  ds_read_b64_tr_b16 a[94:95], v4 offset:50952
  v_mul_f32 v8, s25, v8
  v_mfma_f32_16x16x32_bf16 v[176:179], a[112:115], a[40:43], v[176:179]
  v_mul_f32 v9, s25, v9
  v_cvt_pk_bf16_f32 v225, v8, v9
  v_mfma_f32_16x16x32_bf16 v[176:179], a[120:123], a[44:47], v[176:179]
  v_lshlrev_b32 v8, 16, v226
  v_and_b32 v9, s26, v226
  v_mfma_f32_16x16x32_bf16 v[180:183], a[124:127], a[44:47], v[240:243]
  v_mul_f32 v8, s25, v8
  v_mul_f32 v9, s25, v9
  v_mfma_f32_16x16x32_bf16 v[180:183], a[116:119], a[40:43], v[180:183]
  v_cvt_pk_bf16_f32 v226, v8, v9
  v_lshlrev_b32 v8, 16, v227
  v_mfma_f32_16x16x32_bf16 v[180:183], a[108:111], a[36:39], v[180:183]
  v_exp_f32 v176, v176
  v_mfma_f32_16x16x32_bf16 v[180:183], a[100:103], a[32:35], v[180:183]
  v_exp_f32 v177, v177
  v_mfma_f32_16x16x32_bf16 v[188:191], a[100:103], a[48:51], v[240:243]
  ds_read_b128 a[100:103], v3 offset:25600
  v_cvt_pk_bf16_f32 v200, v176, v177
  v_mfma_f32_16x16x32_bf16 v[188:191], a[108:111], a[52:55], v[188:191]
  ds_read_b128 a[108:111], v3 offset:25856
  v_and_b32 v9, s26, v227
  v_mfma_f32_16x16x32_bf16 v[188:191], a[116:119], a[56:59], v[188:191]
  ds_read_b128 a[116:119], v3 offset:26112
  v_mul_f32 v8, s25, v8
  v_mfma_f32_16x16x32_bf16 v[188:191], a[124:127], a[60:63], v[188:191]
  ds_read_b128 a[124:127], v3 offset:26368
  v_mul_f32 v9, s25, v9
  v_mfma_f32_16x16x32_bf16 v[184:187], a[120:123], a[60:63], v[240:243]
  ds_read_b128 a[120:123], v3 offset:25344
  v_cvt_pk_bf16_f32 v227, v8, v9
  v_mfma_f32_16x16x32_bf16 v[184:187], a[112:115], a[56:59], v[184:187]
  ds_read_b128 a[112:115], v3 offset:25088
  v_lshlrev_b32 v8, 16, v228
  v_mfma_f32_16x16x32_bf16 v[184:187], a[104:107], a[52:55], v[184:187]
  ds_read_b128 a[104:107], v3 offset:24832
  v_and_b32 v9, s26, v228
  v_mfma_f32_16x16x32_bf16 v[184:187], a[96:99], a[48:51], v[184:187]
  s_waitcnt lgkmcnt(5)
  ds_read_b128 a[96:99], v3 offset:24576
  v_mul_f32 v8, s25, v8
  v_mfma_f32_16x16x32_bf16 v[32:35], a[64:67], v[192:195], v[32:35]
  v_exp_f32 v178, v178
  v_mfma_f32_16x16x32_bf16 v[40:43], a[64:67], v[196:199], v[40:43]
  v_exp_f32 v179, v179
  v_mfma_f32_16x16x32_bf16 v[36:39], a[68:71], v[192:195], v[36:39]
  v_exp_f32 v180, v180
  v_mfma_f32_16x16x32_bf16 v[44:47], a[68:71], v[196:199], v[44:47]
  v_exp_f32 v181, v181
  v_smfmac_f32_16x16x64_bf16 v[14:17], v[10:13], v[192:199], v0
  v_cvt_pk_bf16_f32 v201, v178, v179
  v_mfma_f32_16x16x32_bf16 v[48:51], a[72:75], v[192:195], v[48:51]
  v_exp_f32 v182, v182
  v_mfma_f32_16x16x32_bf16 v[56:59], a[72:75], v[196:199], v[56:59]
  v_exp_f32 v183, v183
  v_mfma_f32_16x16x32_bf16 v[52:55], a[76:79], v[192:195], v[52:55]
  v_exp_f32 v184, v184
  v_mfma_f32_16x16x32_bf16 v[60:63], a[76:79], v[196:199], v[60:63]
  v_exp_f32 v185, v185
  v_mfma_f32_16x16x32_bf16 v[64:67], a[80:83], v[192:195], v[64:67]
  v_exp_f32 v186, v186
  v_mfma_f32_16x16x32_bf16 v[72:75], a[80:83], v[196:199], v[72:75]
  v_exp_f32 v187, v187
  v_mfma_f32_16x16x32_bf16 v[68:71], a[84:87], v[192:195], v[68:71]
  v_exp_f32 v188, v188
  v_mfma_f32_16x16x32_bf16 v[76:79], a[84:87], v[196:199], v[76:79]
  v_exp_f32 v189, v189
  v_mfma_f32_16x16x32_bf16 v[80:83], a[88:91], v[192:195], v[80:83]
  v_exp_f32 v190, v190
  v_mfma_f32_16x16x32_bf16 v[88:91], a[88:91], v[196:199], v[88:91]
  v_exp_f32 v191, v191
  v_mfma_f32_16x16x32_bf16 v[84:87], a[92:95], v[192:195], v[84:87]
  v_cvt_pk_bf16_f32 v202, v180, v181
  v_cvt_pk_bf16_f32 v203, v182, v183
  v_mfma_f32_16x16x32_bf16 v[92:95], a[92:95], v[196:199], v[92:95]
  s_waitcnt lgkmcnt(0)
  v_cvt_pk_bf16_f32 v204, v184, v185
  v_cvt_pk_bf16_f32 v205, v186, v187
  v_mfma_f32_16x16x32_bf16 v[160:163], a[96:99], a[0:3], v[240:243]
  v_cvt_pk_bf16_f32 v206, v188, v189
  v_cvt_pk_bf16_f32 v207, v190, v191
  v_mfma_f32_16x16x32_bf16 v[160:163], a[104:107], a[4:7], v[160:163]
  v_mul_f32 v9, s25, v9
  v_cvt_pk_bf16_f32 v228, v8, v9
  v_mfma_f32_16x16x32_bf16 v[160:163], a[112:115], a[8:11], v[160:163]
  v_lshlrev_b32 v8, 16, v229
  v_and_b32 v9, s26, v229
  v_mfma_f32_16x16x32_bf16 v[160:163], a[120:123], a[12:15], v[160:163]
  v_mul_f32 v8, s25, v8
  v_mul_f32 v9, s25, v9
  v_mfma_f32_16x16x32_bf16 v[164:167], a[124:127], a[12:15], v[240:243]
  v_cvt_pk_bf16_f32 v229, v8, v9
  v_lshlrev_b32 v8, 16, v230
  v_mfma_f32_16x16x32_bf16 v[164:167], a[116:119], a[8:11], v[164:167]
  v_and_b32 v9, s26, v230
  v_mul_f32 v8, s25, v8
  v_mfma_f32_16x16x32_bf16 v[164:167], a[108:111], a[4:7], v[164:167]
  v_exp_f32 v160, v160
  v_mfma_f32_16x16x32_bf16 v[164:167], a[100:103], a[0:3], v[164:167]
  v_exp_f32 v161, v161
  v_mfma_f32_16x16x32_bf16 v[172:175], a[100:103], a[16:19], v[240:243]
  v_exp_f32 v162, v162
  v_mfma_f32_16x16x32_bf16 v[172:175], a[108:111], a[20:23], v[172:175]
  v_exp_f32 v163, v163
  v_mfma_f32_16x16x32_bf16 v[172:175], a[116:119], a[24:27], v[172:175]
  v_exp_f32 v164, v164
  v_mfma_f32_16x16x32_bf16 v[172:175], a[124:127], a[28:31], v[172:175]
  v_exp_f32 v165, v165
  v_mfma_f32_16x16x32_bf16 v[168:171], a[120:123], a[28:31], v[240:243]
  v_exp_f32 v166, v166
  v_mfma_f32_16x16x32_bf16 v[168:171], a[112:115], a[24:27], v[168:171]
  v_exp_f32 v167, v167
  v_mfma_f32_16x16x32_bf16 v[168:171], a[104:107], a[20:23], v[168:171]
  s_waitcnt vmcnt(0)
  s_barrier
  v_cvt_pk_bf16_f32 v192, v160, v161
  v_mfma_f32_16x16x32_bf16 v[168:171], a[96:99], a[16:19], v[168:171]
  v_exp_f32 v172, v172
  v_mfma_f32_16x16x32_bf16 v[96:99], a[64:67], v[200:203], v[96:99]
  ds_read_b64_tr_b16 a[0:1], v4 offset:57344
  ds_read_b64_tr_b16 a[2:3], v4 offset:58368
  v_mfma_f32_16x16x32_bf16 v[104:107], a[64:67], v[204:207], v[104:107]
  ds_read_b64_tr_b16 a[4:5], v4 offset:57352
  ds_read_b64_tr_b16 a[6:7], v4 offset:58376
  v_mfma_f32_16x16x32_bf16 v[100:103], a[68:71], v[200:203], v[100:103]
  ds_read_b64_tr_b16 a[8:9], v4 offset:57600
  ds_read_b64_tr_b16 a[10:11], v4 offset:58624
  v_mfma_f32_16x16x32_bf16 v[108:111], a[68:71], v[204:207], v[108:111]
  ds_read_b64_tr_b16 a[12:13], v4 offset:57608
  ds_read_b64_tr_b16 a[14:15], v4 offset:58632
  v_smfmac_f32_16x16x64_bf16 v[20:23], v[10:13], v[200:207], v0
  v_cvt_pk_bf16_f32 v193, v162, v163
  v_mfma_f32_16x16x32_bf16 v[112:115], a[72:75], v[200:203], v[112:115]
  v_exp_f32 v168, v168
  v_mfma_f32_16x16x32_bf16 v[120:123], a[72:75], v[204:207], v[120:123]
  v_exp_f32 v169, v169
  v_mfma_f32_16x16x32_bf16 v[116:119], a[76:79], v[200:203], v[116:119]
  v_exp_f32 v170, v170
  v_mfma_f32_16x16x32_bf16 v[124:127], a[76:79], v[204:207], v[124:127]
  v_exp_f32 v171, v171
  v_mfma_f32_16x16x32_bf16 v[128:131], a[80:83], v[200:203], v[128:131]
  v_exp_f32 v173, v173
  v_mfma_f32_16x16x32_bf16 v[136:139], a[80:83], v[204:207], v[136:139]
  v_exp_f32 v174, v174
  v_mfma_f32_16x16x32_bf16 v[132:135], a[84:87], v[200:203], v[132:135]
  v_exp_f32 v175, v175
  v_mfma_f32_16x16x32_bf16 v[140:143], a[84:87], v[204:207], v[140:143]
  ds_read_b64_tr_b16 a[16:17], v4 offset:57856
  v_cvt_pk_bf16_f32 v194, v164, v165
  v_mfma_f32_16x16x32_bf16 v[144:147], a[88:91], v[200:203], v[144:147]
  ds_read_b64_tr_b16 a[18:19], v4 offset:58880
  v_cvt_pk_bf16_f32 v195, v166, v167
  v_mfma_f32_16x16x32_bf16 v[152:155], a[88:91], v[204:207], v[152:155]
  ds_read_b64_tr_b16 a[20:21], v4 offset:57864
  v_cvt_pk_bf16_f32 v196, v168, v169
  v_mfma_f32_16x16x32_bf16 v[148:151], a[92:95], v[200:203], v[148:151]
  ds_read_b64_tr_b16 a[22:23], v4 offset:58888
  v_cvt_pk_bf16_f32 v197, v170, v171
  v_mfma_f32_16x16x32_bf16 v[156:159], a[92:95], v[204:207], v[156:159]
  s_waitcnt lgkmcnt(4)
  v_cvt_pk_bf16_f32 v198, v172, v173
  v_cvt_pk_bf16_f32 v199, v174, v175
  v_mfma_f32_16x16x32_bf16 v[32:35], a[0:3], v[192:195], v[32:35]
  ds_read_b64_tr_b16 a[24:25], v4 offset:58112
  ds_read_b64_tr_b16 a[26:27], v4 offset:59136
  v_mfma_f32_16x16x32_bf16 v[40:43], a[0:3], v[196:199], v[40:43]
  ds_read_b64_tr_b16 a[28:29], v4 offset:58120
  ds_read_b64_tr_b16 a[30:31], v4 offset:59144
  v_smfmac_f32_16x16x64_bf16 v[14:17], v[10:13], v[192:199], v0
  v_mul_f32 v9, s25, v9
  v_mfma_f32_16x16x32_bf16 v[36:39], a[4:7], v[192:195], v[36:39]
  ds_read_b128 a[64:67], v2 offset:8192
  v_cvt_pk_bf16_f32 v230, v8, v9
  v_mfma_f32_16x16x32_bf16 v[44:47], a[4:7], v[196:199], v[44:47]
  ds_read_b128 a[72:75], v2 offset:8448
  v_lshlrev_b32 v8, 16, v231
  v_mfma_f32_16x16x32_bf16 v[48:51], a[8:11], v[192:195], v[48:51]
  ds_read_b128 a[80:83], v2 offset:8704
  v_and_b32 v9, s26, v231
  v_mfma_f32_16x16x32_bf16 v[56:59], a[8:11], v[196:199], v[56:59]
  ds_read_b128 a[88:91], v2 offset:8960
  v_mul_f32 v8, s25, v8
  v_mfma_f32_16x16x32_bf16 v[52:55], a[12:15], v[192:195], v[52:55]
  ds_read_b128 a[92:95], v2 offset:9984
  v_mul_f32 v9, s25, v9
  v_mfma_f32_16x16x32_bf16 v[60:63], a[12:15], v[196:199], v[60:63]
  s_waitcnt lgkmcnt(5)
  ds_read_b128 a[84:87], v2 offset:9728
  v_cvt_pk_bf16_f32 v231, v8, v9
  v_mfma_f32_16x16x32_bf16 v[64:67], a[16:19], v[192:195], v[64:67]
  ds_read_b128 a[76:79], v2 offset:9472
  v_lshlrev_b32 v8, 16, v232
  v_mfma_f32_16x16x32_bf16 v[72:75], a[16:19], v[196:199], v[72:75]
  ds_read_b128 a[68:71], v2 offset:9216
  v_and_b32 v9, s26, v232
  v_mfma_f32_16x16x32_bf16 v[68:71], a[20:23], v[192:195], v[68:71]
  v_mul_f32 v8, s25, v8
  v_mul_f32 v9, s25, v9
  v_mfma_f32_16x16x32_bf16 v[76:79], a[20:23], v[196:199], v[76:79]
  v_cvt_pk_bf16_f32 v232, v8, v9
  v_lshlrev_b32 v8, 16, v233
  v_mfma_f32_16x16x32_bf16 v[80:83], a[24:27], v[192:195], v[80:83]
  v_and_b32 v9, s26, v233
  v_mul_f32 v8, s25, v8
  v_mfma_f32_16x16x32_bf16 v[88:91], a[24:27], v[196:199], v[88:91]
  v_mul_f32 v9, s25, v9
  v_cvt_pk_bf16_f32 v233, v8, v9
  v_mfma_f32_16x16x32_bf16 v[84:87], a[28:31], v[192:195], v[84:87]
  v_lshlrev_b32 v8, 16, v234
  v_and_b32 v9, s26, v234
  v_mfma_f32_16x16x32_bf16 v[92:95], a[28:31], v[196:199], v[92:95]
  v_mul_f32 v8, s25, v8
  v_mul_f32 v9, s25, v9
  v_mfma_f32_16x16x32_bf16 v[176:179], a[96:99], a[32:35], v[240:243]
  v_cvt_pk_bf16_f32 v234, v8, v9
  v_lshlrev_b32 v8, 16, v235
  v_mfma_f32_16x16x32_bf16 v[176:179], a[104:107], a[36:39], v[176:179]
  v_and_b32 v9, s26, v235
  v_mul_f32 v8, s25, v8
  v_mfma_f32_16x16x32_bf16 v[176:179], a[112:115], a[40:43], v[176:179]
  v_mul_f32 v9, s25, v9
  v_cvt_pk_bf16_f32 v235, v8, v9
  v_mfma_f32_16x16x32_bf16 v[176:179], a[120:123], a[44:47], v[176:179]
  v_add_f32 v15, v14, v15
  v_lshlrev_b32 v8, 16, v236
  v_mfma_f32_16x16x32_bf16 v[180:183], a[124:127], a[44:47], v[240:243]
  v_rcp_f32 v14, v15
  v_mfma_f32_16x16x32_bf16 v[180:183], a[116:119], a[40:43], v[180:183]
  v_mul_f32 v32, v14, v32
  v_mul_f32 v33, v14, v33
  v_mfma_f32_16x16x32_bf16 v[180:183], a[108:111], a[36:39], v[180:183]
  v_cvt_pk_bf16_f32 v244, v32, v33
  v_mul_f32 v34, v14, v34
  v_mfma_f32_16x16x32_bf16 v[180:183], a[100:103], a[32:35], v[180:183]
  v_mul_f32 v35, v14, v35
  v_cvt_pk_bf16_f32 v245, v34, v35
  v_mfma_f32_16x16x32_bf16 v[188:191], a[100:103], a[48:51], v[240:243]
  v_mul_f32 v36, v14, v36
  v_mul_f32 v37, v14, v37
  v_mfma_f32_16x16x32_bf16 v[188:191], a[108:111], a[52:55], v[188:191]
  v_cvt_pk_bf16_f32 v246, v36, v37
  v_mul_f32 v38, v14, v38
  v_mfma_f32_16x16x32_bf16 v[188:191], a[116:119], a[56:59], v[188:191]
  v_mul_f32 v39, v14, v39
  v_cvt_pk_bf16_f32 v247, v38, v39
  v_mfma_f32_16x16x32_bf16 v[188:191], a[124:127], a[60:63], v[188:191]
  buffer_store_dwordx4 v[244:247], v1, s[20:23], s28 offen offset:0 sc1 nt
  v_and_b32 v9, s26, v236
  v_mul_f32 v8, s25, v8
  v_mul_f32 v9, s25, v9
  v_pk_mul_f32 v[48:49], v[48:49], v[14:15] op_sel_hi:[1,0]
  v_pk_mul_f32 v[50:51], v[50:51], v[14:15] op_sel_hi:[1,0]
  v_pk_mul_f32 v[52:53], v[52:53], v[14:15] op_sel_hi:[1,0]
  v_pk_mul_f32 v[54:55], v[54:55], v[14:15] op_sel_hi:[1,0]
  v_cvt_pk_bf16_f32 v236, v8, v9
  v_mfma_f32_16x16x32_bf16 v[184:187], a[120:123], a[60:63], v[240:243]
  v_lshlrev_b32 v8, 16, v237
  v_and_b32 v9, s26, v237
  v_mfma_f32_16x16x32_bf16 v[184:187], a[112:115], a[56:59], v[184:187]
  v_mul_f32 v8, s25, v8
  v_mul_f32 v9, s25, v9
  v_mfma_f32_16x16x32_bf16 v[184:187], a[104:107], a[52:55], v[184:187]
  v_cvt_pk_bf16_f32 v237, v8, v9
  v_lshlrev_b32 v8, 16, v238
  v_and_b32 v9, s26, v238
  v_mul_f32 v8, s25, v8
  v_mul_f32 v9, s25, v9
  v_cvt_pk_bf16_f32 v238, v8, v9
  v_lshlrev_b32 v8, 16, v239
  v_and_b32 v9, s26, v239
  v_pk_mul_f32 v[8:9], v[8:9], s[62:63]
  v_cvt_pk_bf16_f32 v239, v8, v9
  v_mfma_f32_16x16x32_bf16 v[184:187], a[96:99], a[48:51], v[184:187]
  v_add_f32 v17, v16, v17
  v_cvt_pk_bf16_f32 v252, v48, v49
  v_mfma_f32_16x16x32_bf16 v[160:163], a[96:99], v[208:211], v[240:243]
  v_rcp_f32 v16, v17
  v_mfma_f32_16x16x32_bf16 v[160:163], a[104:107], v[212:215], v[160:163]
  ds_read_b128 a[32:35], v2 offset:0
  v_mul_f32 v40, v16, v40
  v_mfma_f32_16x16x32_bf16 v[160:163], a[112:115], v[216:219], v[160:163]
  ds_read_b128 a[40:43], v2 offset:256
  v_mul_f32 v41, v16, v41
  v_mfma_f32_16x16x32_bf16 v[160:163], a[120:123], v[220:223], v[160:163]
  ds_read_b128 a[48:51], v2 offset:512
  v_cvt_pk_bf16_f32 v248, v40, v41
  v_mfma_f32_16x16x32_bf16 v[164:167], a[124:127], v[220:223], v[240:243]
  ds_read_b128 a[56:59], v2 offset:768
  v_mul_f32 v42, v16, v42
  v_mfma_f32_16x16x32_bf16 v[164:167], a[116:119], v[216:219], v[164:167]
  ds_read_b128 a[60:63], v2 offset:1792
  v_mul_f32 v43, v16, v43
  v_mfma_f32_16x16x32_bf16 v[164:167], a[108:111], v[212:215], v[164:167]
  ds_read_b128 a[52:55], v2 offset:1536
  v_cvt_pk_bf16_f32 v249, v42, v43
  v_mfma_f32_16x16x32_bf16 v[164:167], a[100:103], v[208:211], v[164:167]
  v_mul_f32 v44, v16, v44
  v_mul_f32 v45, v16, v45
  v_cvt_pk_bf16_f32 v250, v44, v45
  v_mul_f32 v46, v16, v46
  v_mul_f32 v47, v16, v47
  v_cvt_pk_bf16_f32 v251, v46, v47
  v_mfma_f32_16x16x32_bf16 v[172:175], a[100:103], v[224:227], v[240:243]
  buffer_store_dwordx4 v[248:251], v1, s[20:23], s56 offen offset:0 sc1 nt
  v_exp_f32 v176, v176
  v_pk_mul_f32 v[56:57], v[56:57], v[16:17] op_sel_hi:[1,0]
  v_pk_mul_f32 v[58:59], v[58:59], v[16:17] op_sel_hi:[1,0]
  v_pk_mul_f32 v[60:61], v[60:61], v[16:17] op_sel_hi:[1,0]
  v_pk_mul_f32 v[62:63], v[62:63], v[16:17] op_sel_hi:[1,0]
  v_exp_f32 v177, v177
  v_mfma_f32_16x16x32_bf16 v[172:175], a[108:111], v[228:231], v[172:175]
  v_exp_f32 v178, v178
  v_mfma_f32_16x16x32_bf16 v[172:175], a[116:119], v[232:235], v[172:175]
  v_exp_f32 v179, v179
  v_mfma_f32_16x16x32_bf16 v[172:175], a[124:127], v[236:239], v[172:175]
  v_exp_f32 v180, v180
  v_mfma_f32_16x16x32_bf16 v[168:171], a[120:123], v[236:239], v[240:243]
  v_exp_f32 v181, v181
  v_mfma_f32_16x16x32_bf16 v[168:171], a[112:115], v[232:235], v[168:171]
  v_exp_f32 v182, v182
  v_exp_f32 v183, v183
  v_mfma_f32_16x16x32_bf16 v[168:171], a[104:107], v[228:231], v[168:171]
  v_cvt_pk_bf16_f32 v200, v176, v177
  v_cvt_pk_bf16_f32 v201, v178, v179
  v_cvt_pk_bf16_f32 v202, v180, v181
  v_cvt_pk_bf16_f32 v203, v182, v183
  v_exp_f32 v184, v184
  v_exp_f32 v185, v185
  v_exp_f32 v186, v186
  v_exp_f32 v187, v187
  v_exp_f32 v188, v188
  v_exp_f32 v189, v189
  v_exp_f32 v190, v190
  v_exp_f32 v191, v191
  v_mfma_f32_16x16x32_bf16 v[168:171], a[96:99], v[224:227], v[168:171]
  v_cvt_pk_bf16_f32 v204, v184, v185
  v_cvt_pk_bf16_f32 v205, v186, v187
  v_cvt_pk_bf16_f32 v206, v188, v189
  v_cvt_pk_bf16_f32 v207, v190, v191
  v_mfma_f32_16x16x32_bf16 v[96:99], a[0:3], v[200:203], v[96:99]
  ds_read_b128 a[44:47], v2 offset:1280
  v_cvt_pk_bf16_f32 v253, v50, v51
  v_mfma_f32_16x16x32_bf16 v[104:107], a[0:3], v[204:207], v[104:107]
  ds_read_b128 a[36:39], v2 offset:1024
  v_cvt_pk_bf16_f32 v254, v52, v53
  v_smfmac_f32_16x16x64_bf16 v[20:23], v[10:13], v[200:207], v0
  v_cvt_pk_bf16_f32 v255, v54, v55
  v_mfma_f32_16x16x32_bf16 v[100:103], a[4:7], v[200:203], v[100:103]
  buffer_store_dwordx4 v[252:255], v1, s[20:23], s28 offen offset:64 sc1 nt
  ds_read_b128 a[100:103], v2 offset:17408
  v_cvt_pk_bf16_f32 v244, v56, v57
  v_cvt_pk_bf16_f32 v245, v58, v59
  v_pk_mul_f32 v[64:65], v[64:65], v[14:15] op_sel_hi:[1,0]
  v_pk_mul_f32 v[66:67], v[66:67], v[14:15] op_sel_hi:[1,0]
  v_pk_mul_f32 v[68:69], v[68:69], v[14:15] op_sel_hi:[1,0]
  v_pk_mul_f32 v[70:71], v[70:71], v[14:15] op_sel_hi:[1,0]
  v_cvt_pk_bf16_f32 v246, v60, v61
  v_mfma_f32_16x16x32_bf16 v[108:111], a[4:7], v[204:207], v[108:111]
  ds_read_b128 a[108:111], v2 offset:17664
  v_cvt_pk_bf16_f32 v247, v62, v63
  v_mfma_f32_16x16x32_bf16 v[112:115], a[8:11], v[200:203], v[112:115]
  buffer_store_dwordx4 v[244:247], v1, s[20:23], s56 offen offset:64 sc1 nt
  ds_read_b128 a[116:119], v2 offset:17920
  v_cvt_pk_bf16_f32 v248, v64, v65
  v_cvt_pk_bf16_f32 v249, v66, v67
  v_pk_mul_f32 v[72:73], v[72:73], v[16:17] op_sel_hi:[1,0]
  v_pk_mul_f32 v[74:75], v[74:75], v[16:17] op_sel_hi:[1,0]
  v_pk_mul_f32 v[76:77], v[76:77], v[16:17] op_sel_hi:[1,0]
  v_pk_mul_f32 v[78:79], v[78:79], v[16:17] op_sel_hi:[1,0]
  v_cvt_pk_bf16_f32 v250, v68, v69
  v_mfma_f32_16x16x32_bf16 v[120:123], a[8:11], v[204:207], v[120:123]
  ds_read_b128 a[124:127], v2 offset:18176
  v_cvt_pk_bf16_f32 v251, v70, v71
  v_mfma_f32_16x16x32_bf16 v[116:119], a[12:15], v[200:203], v[116:119]
  buffer_store_dwordx4 v[248:251], v1, s[20:23], s28 offen offset:128 sc1 nt
  v_exp_f32 v160, v160
  v_pk_mul_f32 v[80:81], v[80:81], v[14:15] op_sel_hi:[1,0]
  v_pk_mul_f32 v[82:83], v[82:83], v[14:15] op_sel_hi:[1,0]
  v_pk_mul_f32 v[88:89], v[88:89], v[16:17] op_sel_hi:[1,0]
  v_pk_mul_f32 v[90:91], v[90:91], v[16:17] op_sel_hi:[1,0]
  v_exp_f32 v161, v161
  v_mfma_f32_16x16x32_bf16 v[124:127], a[12:15], v[204:207], v[124:127]
  v_exp_f32 v162, v162
  v_mfma_f32_16x16x32_bf16 v[128:131], a[16:19], v[200:203], v[128:131]
  v_exp_f32 v163, v163
  v_mfma_f32_16x16x32_bf16 v[136:139], a[16:19], v[204:207], v[136:139]
  v_exp_f32 v164, v164
  v_mfma_f32_16x16x32_bf16 v[132:135], a[20:23], v[200:203], v[132:135]
  v_exp_f32 v165, v165
  v_mfma_f32_16x16x32_bf16 v[140:143], a[20:23], v[204:207], v[140:143]
  v_exp_f32 v166, v166
  v_mfma_f32_16x16x32_bf16 v[144:147], a[24:27], v[200:203], v[144:147]
  v_exp_f32 v167, v167
  v_mfma_f32_16x16x32_bf16 v[152:155], a[24:27], v[204:207], v[152:155]
  v_exp_f32 v168, v168
  v_mfma_f32_16x16x32_bf16 v[148:151], a[28:31], v[200:203], v[148:151]
  v_exp_f32 v169, v169
  v_mfma_f32_16x16x32_bf16 v[156:159], a[28:31], v[204:207], v[156:159]
  s_waitcnt lgkmcnt(0)
  v_exp_f32 v170, v170
  v_mfma_f32_16x16x32_bf16 v[176:179], a[32:35], v[208:211], v[240:243]
  v_exp_f32 v171, v171
  v_mfma_f32_16x16x32_bf16 v[176:179], a[40:43], v[212:215], v[176:179]
  v_exp_f32 v172, v172
  v_mfma_f32_16x16x32_bf16 v[176:179], a[48:51], v[216:219], v[176:179]
  v_exp_f32 v173, v173
  v_mfma_f32_16x16x32_bf16 v[176:179], a[56:59], v[220:223], v[176:179]
  v_exp_f32 v174, v174
  v_mfma_f32_16x16x32_bf16 v[180:183], a[60:63], v[220:223], v[240:243]
  v_exp_f32 v175, v175
  v_mfma_f32_16x16x32_bf16 v[180:183], a[52:55], v[216:219], v[180:183]
  ds_read_b128 a[120:123], v2 offset:17152
  v_cvt_pk_bf16_f32 v192, v160, v161
  v_mfma_f32_16x16x32_bf16 v[180:183], a[44:47], v[212:215], v[180:183]
  ds_read_b128 a[112:115], v2 offset:16896
  v_cvt_pk_bf16_f32 v193, v162, v163
  v_mfma_f32_16x16x32_bf16 v[180:183], a[36:39], v[208:211], v[180:183]
  ds_read_b128 a[104:107], v2 offset:16640
  v_cvt_pk_bf16_f32 v194, v164, v165
  v_mfma_f32_16x16x32_bf16 v[188:191], a[36:39], v[224:227], v[240:243]
  ds_read_b128 a[96:99], v2 offset:16384
  v_cvt_pk_bf16_f32 v195, v166, v167
  v_mfma_f32_16x16x32_bf16 v[188:191], a[44:47], v[228:231], v[188:191]
  ds_read_b128 a[44:47], v2 offset:25856
  v_cvt_pk_bf16_f32 v196, v168, v169
  v_mfma_f32_16x16x32_bf16 v[188:191], a[52:55], v[232:235], v[188:191]
  ds_read_b128 a[52:55], v2 offset:26112
  v_cvt_pk_bf16_f32 v197, v170, v171
  v_mfma_f32_16x16x32_bf16 v[188:191], a[60:63], v[236:239], v[188:191]
  ds_read_b128 a[60:63], v2 offset:26368
  v_cvt_pk_bf16_f32 v198, v172, v173
  v_mfma_f32_16x16x32_bf16 v[184:187], a[56:59], v[236:239], v[240:243]
  ds_read_b128 a[56:59], v2 offset:25344
  v_cvt_pk_bf16_f32 v199, v174, v175
  v_mfma_f32_16x16x32_bf16 v[184:187], a[48:51], v[232:235], v[184:187]
  ds_read_b128 a[48:51], v2 offset:25088
  v_cvt_pk_bf16_f32 v252, v72, v73
  v_mfma_f32_16x16x32_bf16 v[184:187], a[40:43], v[228:231], v[184:187]
  ds_read_b128 a[40:43], v2 offset:24832
  v_cvt_pk_bf16_f32 v253, v74, v75
  v_mfma_f32_16x16x32_bf16 v[184:187], a[32:35], v[224:227], v[184:187]
  ds_read_b128 a[32:35], v2 offset:24576
  v_cvt_pk_bf16_f32 v254, v76, v77
  v_mfma_f32_16x16x32_bf16 v[32:35], a[0:3], v[192:195], 0
  ds_read_b128 a[36:39], v2 offset:25600
  v_cvt_pk_bf16_f32 v255, v78, v79
  v_mfma_f32_16x16x32_bf16 v[40:43], a[0:3], v[196:199], 0
  buffer_store_dwordx4 v[252:255], v1, s[20:23], s56 offen offset:128 sc1 nt
  ds_read_b128 a[0:3], v2 offset:32768
  v_cvt_pk_bf16_f32 v244, v80, v81
  v_cvt_pk_bf16_f32 v245, v82, v83
  v_pk_mul_f32 v[84:85], v[84:85], v[14:15] op_sel_hi:[1,0]
  v_pk_mul_f32 v[86:87], v[86:87], v[14:15] op_sel_hi:[1,0]
  v_pk_mul_f32 v[92:93], v[92:93], v[16:17] op_sel_hi:[1,0]
  v_pk_mul_f32 v[94:95], v[94:95], v[16:17] op_sel_hi:[1,0]
  v_cvt_pk_bf16_f32 v248, v88, v89
  v_mfma_f32_16x16x32_bf16 v[36:39], a[4:7], v[192:195], 0
  v_cvt_pk_bf16_f32 v249, v90, v91
  v_cvt_pk_bf16_f32 v246, v84, v85
  v_mfma_f32_16x16x32_bf16 v[44:47], a[4:7], v[196:199], 0
  ds_read_b128 a[4:7], v2 offset:33792
  v_cvt_pk_bf16_f32 v247, v86, v87
  v_smfmac_f32_16x16x64_bf16 v[26:29], v[10:13], v[192:199], v0
  v_cvt_pk_bf16_f32 v250, v92, v93
  v_mfma_f32_16x16x32_bf16 v[48:51], a[8:11], v[192:195], 0
  buffer_store_dwordx4 v[244:247], v1, s[20:23], s28 offen offset:192 sc1 nt
  v_cvt_pk_bf16_f32 v251, v94, v95
  v_exp_f32 v176, v176
  v_add_f32 v21, v20, v21
  v_mfma_f32_16x16x32_bf16 v[56:59], a[8:11], v[196:199], 0
  buffer_store_dwordx4 v[248:251], v1, s[20:23], s56 offen offset:192 sc1 nt
  v_exp_f32 v177, v177
  v_exp_f32 v178, v178
  v_mfma_f32_16x16x32_bf16 v[52:55], a[12:15], v[192:195], 0
  v_exp_f32 v179, v179
  v_mfma_f32_16x16x32_bf16 v[60:63], a[12:15], v[196:199], 0
  v_exp_f32 v180, v180
  v_mfma_f32_16x16x32_bf16 v[64:67], a[16:19], v[192:195], 0
  v_exp_f32 v181, v181
  v_mfma_f32_16x16x32_bf16 v[72:75], a[16:19], v[196:199], 0
  v_exp_f32 v182, v182
  v_mfma_f32_16x16x32_bf16 v[68:71], a[20:23], v[192:195], 0
  v_exp_f32 v183, v183
  v_mfma_f32_16x16x32_bf16 v[76:79], a[20:23], v[196:199], 0
  v_exp_f32 v184, v184
  v_mfma_f32_16x16x32_bf16 v[80:83], a[24:27], v[192:195], 0
  v_exp_f32 v185, v185
  v_mfma_f32_16x16x32_bf16 v[88:91], a[24:27], v[196:199], 0
  v_exp_f32 v186, v186
  v_mfma_f32_16x16x32_bf16 v[84:87], a[28:31], v[192:195], 0
  v_exp_f32 v187, v187
  v_mfma_f32_16x16x32_bf16 v[92:95], a[28:31], v[196:199], 0
  v_exp_f32 v188, v188
  v_mfma_f32_16x16x32_bf16 v[160:163], a[64:67], v[208:211], v[240:243]
  v_exp_f32 v189, v189
  v_mfma_f32_16x16x32_bf16 v[160:163], a[72:75], v[212:215], v[160:163]
  v_exp_f32 v190, v190
  v_mfma_f32_16x16x32_bf16 v[160:163], a[80:83], v[216:219], v[160:163]
  v_exp_f32 v191, v191
  v_mfma_f32_16x16x32_bf16 v[160:163], a[88:91], v[220:223], v[160:163]
  ds_read_b128 a[12:15], v2 offset:34048
  v_cvt_pk_bf16_f32 v200, v176, v177
  v_mfma_f32_16x16x32_bf16 v[164:167], a[92:95], v[220:223], v[240:243]
  ds_read_b128 a[20:23], v2 offset:34304
  v_cvt_pk_bf16_f32 v201, v178, v179
  v_mfma_f32_16x16x32_bf16 v[164:167], a[84:87], v[216:219], v[164:167]
  ds_read_b128 a[28:31], v2 offset:34560
  v_cvt_pk_bf16_f32 v202, v180, v181
  v_mfma_f32_16x16x32_bf16 v[164:167], a[76:79], v[212:215], v[164:167]
  ds_read_b128 a[24:27], v2 offset:33536
  v_cvt_pk_bf16_f32 v203, v182, v183
  v_mfma_f32_16x16x32_bf16 v[164:167], a[68:71], v[208:211], v[164:167]
  ds_read_b128 a[16:19], v2 offset:33280
  v_cvt_pk_bf16_f32 v204, v184, v185
  v_mfma_f32_16x16x32_bf16 v[172:175], a[100:103], v[208:211], v[240:243]
  ds_read_b128 a[8:11], v2 offset:33024
  v_cvt_pk_bf16_f32 v205, v186, v187
  v_mfma_f32_16x16x32_bf16 v[172:175], a[108:111], v[212:215], v[172:175]
  v_cvt_pk_bf16_f32 v206, v188, v189
  v_cvt_pk_bf16_f32 v207, v190, v191
  v_mfma_f32_16x16x32_bf16 v[172:175], a[116:119], v[216:219], v[172:175]
  v_add_f32 v18, v18, v19
  v_add_f32 v21, v21, v18
  v_mfma_f32_16x16x32_bf16 v[172:175], a[124:127], v[220:223], v[172:175]
  s_waitcnt lgkmcnt(3)
  v_rcp_f32 v20, v21
  v_mfma_f32_16x16x32_bf16 v[168:171], a[120:123], v[220:223], v[240:243]
  v_exp_f32 v160, v160
  v_mfma_f32_16x16x32_bf16 v[168:171], a[112:115], v[216:219], v[168:171]
  v_exp_f32 v161, v161
  v_mfma_f32_16x16x32_bf16 v[168:171], a[104:107], v[212:215], v[168:171]
  v_exp_f32 v162, v162
  v_mfma_f32_16x16x32_bf16 v[168:171], a[96:99], v[208:211], v[168:171]
  v_exp_f32 v163, v163
  v_mfma_f32_16x16x32_bf16 v[32:35], a[128:131], v[200:203], v[32:35]
  v_exp_f32 v164, v164
  v_mfma_f32_16x16x32_bf16 v[40:43], a[128:131], v[204:207], v[40:43]
  v_exp_f32 v165, v165
  v_mfma_f32_16x16x32_bf16 v[36:39], a[132:135], v[200:203], v[36:39]
L_t4:
  s_cbranch_vccnz L_back
  v_exp_f32 v166, v166
  v_mfma_f32_16x16x32_bf16 v[44:47], a[132:135], v[204:207], v[44:47]
  v_exp_f32 v167, v167
  v_smfmac_f32_16x16x64_bf16 v[26:29], v[10:13], v[200:207], v0
  v_mul_f32 v96, v20, v96
  v_mfma_f32_16x16x32_bf16 v[48:51], a[136:139], v[200:203], v[48:51]
  ds_read_b64_tr_b16 a[128:129], v4 offset:0
  v_mul_f32 v97, v20, v97
  v_mfma_f32_16x16x32_bf16 v[56:59], a[136:139], v[204:207], v[56:59]
  ds_read_b64_tr_b16 a[130:131], v4 offset:1024
  v_cvt_pk_bf16_f32 v96, v96, v97
  v_mfma_f32_16x16x32_bf16 v[52:55], a[140:143], v[200:203], v[52:55]
  ds_read_b64_tr_b16 a[132:133], v4 offset:8
  v_mul_f32 v98, v20, v98
  v_mfma_f32_16x16x32_bf16 v[60:63], a[140:143], v[204:207], v[60:63]
  ds_read_b64_tr_b16 a[134:135], v4 offset:1032
  v_mul_f32 v99, v20, v99
  v_mfma_f32_16x16x32_bf16 v[64:67], a[144:147], v[200:203], v[64:67]
  ds_read_b64_tr_b16 a[136:137], v4 offset:256
  v_cvt_pk_bf16_f32 v97, v98, v99
  v_mfma_f32_16x16x32_bf16 v[72:75], a[144:147], v[204:207], v[72:75]
  ds_read_b64_tr_b16 a[138:139], v4 offset:1280
  v_mul_f32 v100, v20, v100
  v_mfma_f32_16x16x32_bf16 v[68:71], a[148:151], v[200:203], v[68:71]
  ds_read_b64_tr_b16 a[140:141], v4 offset:264
  v_mul_f32 v101, v20, v101
  v_mfma_f32_16x16x32_bf16 v[76:79], a[148:151], v[204:207], v[76:79]
  ds_read_b64_tr_b16 a[142:143], v4 offset:1288
  v_cvt_pk_bf16_f32 v98, v100, v101
  v_mfma_f32_16x16x32_bf16 v[80:83], a[152:155], v[200:203], v[80:83]
  ds_read_b64_tr_b16 a[144:145], v4 offset:512
  v_mul_f32 v102, v20, v102
  v_mfma_f32_16x16x32_bf16 v[88:91], a[152:155], v[204:207], v[88:91]
  ds_read_b64_tr_b16 a[146:147], v4 offset:1536
  v_mul_f32 v103, v20, v103
  v_mfma_f32_16x16x32_bf16 v[84:87], a[156:159], v[200:203], v[84:87]
  ds_read_b64_tr_b16 a[148:149], v4 offset:520
  v_cvt_pk_bf16_f32 v99, v102, v103
  v_mfma_f32_16x16x32_bf16 v[92:95], a[156:159], v[204:207], v[92:95]
  buffer_store_dwordx4 v[96:99], v1, s[20:23], s29 offen offset:0 sc1 nt
  v_exp_f32 v168, v168
  v_pk_mul_f32 v[112:113], v[112:113], v[20:21] op_sel_hi:[1,0]
  v_pk_mul_f32 v[114:115], v[114:115], v[20:21] op_sel_hi:[1,0]
  v_pk_mul_f32 v[116:117], v[116:117], v[20:21] op_sel_hi:[1,0]
  v_pk_mul_f32 v[118:119], v[118:119], v[20:21] op_sel_hi:[1,0]
  v_exp_f32 v169, v169
  v_mfma_f32_16x16x32_bf16 v[176:179], a[64:67], v[224:227], v[240:243]
  v_exp_f32 v170, v170
  v_mfma_f32_16x16x32_bf16 v[176:179], a[72:75], v[228:231], v[176:179]
  v_exp_f32 v171, v171
  v_mfma_f32_16x16x32_bf16 v[176:179], a[80:83], v[232:235], v[176:179]
  v_exp_f32 v172, v172
  v_mfma_f32_16x16x32_bf16 v[176:179], a[88:91], v[236:239], v[176:179]
  v_exp_f32 v173, v173
  v_mfma_f32_16x16x32_bf16 v[180:183], a[92:95], v[236:239], v[240:243]
  v_exp_f32 v174, v174
  v_mfma_f32_16x16x32_bf16 v[180:183], a[84:87], v[232:235], v[180:183]
  v_exp_f32 v175, v175
  v_mfma_f32_16x16x32_bf16 v[180:183], a[76:79], v[228:231], v[180:183]
  ds_read_b64_tr_b16 a[150:151], v4 offset:1544
  v_cvt_pk_bf16_f32 v192, v160, v161
  v_mfma_f32_16x16x32_bf16 v[180:183], a[68:71], v[224:227], v[180:183]
  ds_read_b64_tr_b16 a[152:153], v4 offset:768
  v_cvt_pk_bf16_f32 v193, v162, v163
  v_mfma_f32_16x16x32_bf16 v[188:191], a[100:103], v[224:227], v[240:243]
  ds_read_b64_tr_b16 a[154:155], v4 offset:1792
  v_cvt_pk_bf16_f32 v194, v164, v165
  v_mfma_f32_16x16x32_bf16 v[188:191], a[108:111], v[228:231], v[188:191]
  ds_read_b64_tr_b16 a[156:157], v4 offset:776
  v_cvt_pk_bf16_f32 v195, v166, v167
  v_mfma_f32_16x16x32_bf16 v[188:191], a[116:119], v[232:235], v[188:191]
  ds_read_b64_tr_b16 a[158:159], v4 offset:1800
  v_cvt_pk_bf16_f32 v196, v168, v169
  v_mfma_f32_16x16x32_bf16 v[188:191], a[124:127], v[236:239], v[188:191]
  ds_read_b128 a[64:67], v2 offset:40960
  v_cvt_pk_bf16_f32 v197, v170, v171
  v_mfma_f32_16x16x32_bf16 v[184:187], a[120:123], v[236:239], v[240:243]
  ds_read_b128 a[72:75], v2 offset:41216
  v_cvt_pk_bf16_f32 v198, v172, v173
  v_mfma_f32_16x16x32_bf16 v[184:187], a[112:115], v[232:235], v[184:187]
  ds_read_b128 a[80:83], v2 offset:41472
  v_cvt_pk_bf16_f32 v199, v174, v175
  v_mfma_f32_16x16x32_bf16 v[184:187], a[104:107], v[228:231], v[184:187]
  ds_read_b128 a[88:91], v2 offset:41728
  v_add_f32 v23, v22, v23
  v_mfma_f32_16x16x32_bf16 v[184:187], a[96:99], v[224:227], v[184:187]
  ds_read_b128 a[92:95], v2 offset:42752
  v_add_f32 v24, v24, v25
  v_mfma_f32_16x16x32_bf16 v[32:35], a[160:163], v[192:195], v[32:35]
  ds_read_b128 a[84:87], v2 offset:42496
  v_add_f32 v23, v23, v24
  v_mfma_f32_16x16x32_bf16 v[32:35], a[192:195], v[196:199], v[32:35]
  ds_read_b128 a[76:79], v2 offset:42240
  v_mov_b32 v24, 0
  v_mfma_f32_16x16x32_bf16 v[36:39], a[164:167], v[192:195], v[36:39]
  v_mov_b32 v25, 0
  v_cvt_pk_bf16_f32 v112, v112, v113
  v_mfma_f32_16x16x32_bf16 v[36:39], a[196:199], v[196:199], v[36:39]
  v_rcp_f32 v22, v23
  v_smfmac_f32_16x16x64_bf16 v[24:27], v[10:13], v[192:199], v0
  v_mul_f32 v104, v22, v104
  v_mfma_f32_16x16x32_bf16 v[48:51], a[168:171], v[192:195], v[48:51]
  ds_read_b128 a[68:71], v2 offset:41984
  v_mul_f32 v105, v22, v105
  v_mfma_f32_16x16x32_bf16 v[48:51], a[200:203], v[196:199], v[48:51]
  ds_read_b128 a[100:103], v2 offset:50176
  v_cvt_pk_bf16_f32 v104, v104, v105
  v_mfma_f32_16x16x32_bf16 v[52:55], a[172:175], v[192:195], v[52:55]
  ds_read_b128 a[108:111], v2 offset:50432
  v_mul_f32 v106, v22, v106
  v_mfma_f32_16x16x32_bf16 v[52:55], a[204:207], v[196:199], v[52:55]
  ds_read_b128 a[116:119], v2 offset:50688
  v_mul_f32 v107, v22, v107
  v_mfma_f32_16x16x32_bf16 v[64:67], a[176:179], v[192:195], v[64:67]
  ds_read_b128 a[124:127], v2 offset:50944
  v_cvt_pk_bf16_f32 v105, v106, v107
  v_mfma_f32_16x16x32_bf16 v[64:67], a[208:211], v[196:199], v[64:67]
  ds_read_b128 a[120:123], v2 offset:49920
  v_mul_f32 v108, v22, v108
  v_mfma_f32_16x16x32_bf16 v[68:71], a[180:183], v[192:195], v[68:71]
  ds_read_b128 a[112:115], v2 offset:49664
  v_mul_f32 v109, v22, v109
  v_mfma_f32_16x16x32_bf16 v[68:71], a[212:215], v[196:199], v[68:71]
  ds_read_b128 a[104:107], v2 offset:49408
  v_cvt_pk_bf16_f32 v106, v108, v109
  v_mfma_f32_16x16x32_bf16 v[80:83], a[184:187], v[192:195], v[80:83]
  ds_read_b128 a[96:99], v2 offset:49152
  v_mul_f32 v110, v22, v110
  v_mfma_f32_16x16x32_bf16 v[80:83], a[216:219], v[196:199], v[80:83]
  v_mul_f32 v111, v22, v111
  v_cvt_pk_bf16_f32 v107, v110, v111
  v_mfma_f32_16x16x32_bf16 v[84:87], a[188:191], v[192:195], v[84:87]
  buffer_store_dwordx4 v[104:107], v1, s[20:23], s57 offen offset:0 sc1 nt
  v_exp_f32 v176, v176
  v_pk_mul_f32 v[120:121], v[120:121], v[22:23] op_sel_hi:[1,0]
  v_pk_mul_f32 v[122:123], v[122:123], v[22:23] op_sel_hi:[1,0]
  v_pk_mul_f32 v[124:125], v[124:125], v[22:23] op_sel_hi:[1,0]
  v_pk_mul_f32 v[126:127], v[126:127], v[22:23] op_sel_hi:[1,0]
  v_exp_f32 v177, v177
  v_mfma_f32_16x16x32_bf16 v[84:87], a[220:223], v[196:199], v[84:87]
  v_exp_f32 v178, v178
  v_mfma_f32_16x16x32_bf16 v[160:163], a[32:35], v[208:211], v[240:243]
  v_exp_f32 v179, v179
  v_mfma_f32_16x16x32_bf16 v[160:163], a[40:43], v[212:215], v[160:163]
  v_exp_f32 v180, v180
  v_mfma_f32_16x16x32_bf16 v[160:163], a[48:51], v[216:219], v[160:163]
  v_exp_f32 v181, v181
  v_mfma_f32_16x16x32_bf16 v[160:163], a[56:59], v[220:223], v[160:163]
  v_exp_f32 v182, v182
  v_mfma_f32_16x16x32_bf16 v[164:167], a[60:63], v[220:223], v[240:243]
  v_exp_f32 v183, v183
  v_mfma_f32_16x16x32_bf16 v[164:167], a[52:55], v[216:219], v[164:167]
  v_exp_f32 v184, v184
  v_mfma_f32_16x16x32_bf16 v[164:167], a[44:47], v[212:215], v[164:167]
  v_exp_f32 v185, v185
  v_mfma_f32_16x16x32_bf16 v[164:167], a[36:39], v[208:211], v[164:167]
  v_exp_f32 v186, v186
  v_mfma_f32_16x16x32_bf16 v[172:175], a[4:7], v[208:211], v[240:243]
  v_exp_f32 v187, v187
  v_mfma_f32_16x16x32_bf16 v[172:175], a[12:15], v[212:215], v[172:175]
  v_exp_f32 v188, v188
  v_mfma_f32_16x16x32_bf16 v[172:175], a[20:23], v[216:219], v[172:175]
  v_exp_f32 v189, v189
  v_mfma_f32_16x16x32_bf16 v[172:175], a[28:31], v[220:223], v[172:175]
  s_waitcnt lgkmcnt(0)
  v_exp_f32 v190, v190
  v_mfma_f32_16x16x32_bf16 v[168:171], a[24:27], v[220:223], v[240:243]
  v_exp_f32 v191, v191
  v_mfma_f32_16x16x32_bf16 v[168:171], a[16:19], v[216:219], v[168:171]
  v_cvt_pk_bf16_f32 v200, v176, v177
  v_cvt_pk_bf16_f32 v201, v178, v179
  v_mfma_f32_16x16x32_bf16 v[168:171], a[8:11], v[212:215], v[168:171]
  v_cvt_pk_bf16_f32 v202, v180, v181
  v_cvt_pk_bf16_f32 v203, v182, v183
  v_mfma_f32_16x16x32_bf16 v[168:171], a[0:3], v[208:211], v[168:171]
  v_cvt_pk_bf16_f32 v204, v184, v185
  v_cvt_pk_bf16_f32 v205, v186, v187
  v_cvt_pk_bf16_f32 v206, v188, v189
  v_cvt_pk_bf16_f32 v207, v190, v191
  v_mfma_f32_16x16x32_bf16 v[40:43], a[160:163], v[200:203], v[40:43]
  ds_read_b64_tr_b16 a[160:161], v4 offset:8192
  v_cvt_pk_bf16_f32 v113, v114, v115
  v_mfma_f32_16x16x32_bf16 v[40:43], a[192:195], v[204:207], v[40:43]
  ds_read_b64_tr_b16 a[162:163], v4 offset:9216
  v_cvt_pk_bf16_f32 v114, v116, v117
  v_mfma_f32_16x16x32_bf16 v[44:47], a[164:167], v[200:203], v[44:47]
  ds_read_b64_tr_b16 a[192:193], v4 offset:16384
  v_cvt_pk_bf16_f32 v115, v118, v119
  v_mfma_f32_16x16x32_bf16 v[44:47], a[196:199], v[204:207], v[44:47]
  buffer_store_dwordx4 v[112:115], v1, s[20:23], s29 offen offset:64 sc1 nt
  v_exp_f32 v160, v160
  v_pk_mul_f32 v[128:129], v[128:129], v[20:21] op_sel_hi:[1,0]
  v_pk_mul_f32 v[130:131], v[130:131], v[20:21] op_sel_hi:[1,0]
  v_pk_mul_f32 v[132:133], v[132:133], v[20:21] op_sel_hi:[1,0]
  v_pk_mul_f32 v[134:135], v[134:135], v[20:21] op_sel_hi:[1,0]
  v_exp_f32 v161, v161
  v_smfmac_f32_16x16x64_bf16 v[28:31], v[10:13], v[200:207], v0
  v_cvt_pk_bf16_f32 v192, v160, v161
  v_mfma_f32_16x16x32_bf16 v[56:59], a[168:171], v[200:203], v[56:59]
  v_exp_f32 v162, v162
  v_mfma_f32_16x16x32_bf16 v[56:59], a[200:203], v[204:207], v[56:59]
  v_exp_f32 v163, v163
  v_mfma_f32_16x16x32_bf16 v[60:63], a[172:175], v[200:203], v[60:63]
  v_exp_f32 v164, v164
  v_mfma_f32_16x16x32_bf16 v[60:63], a[204:207], v[204:207], v[60:63]
  v_exp_f32 v165, v165
  v_mfma_f32_16x16x32_bf16 v[72:75], a[176:179], v[200:203], v[72:75]
  v_exp_f32 v166, v166
  v_mfma_f32_16x16x32_bf16 v[72:75], a[208:211], v[204:207], v[72:75]
  v_exp_f32 v167, v167
  v_mfma_f32_16x16x32_bf16 v[76:79], a[180:183], v[200:203], v[76:79]
  v_exp_f32 v168, v168
  v_mfma_f32_16x16x32_bf16 v[76:79], a[212:215], v[204:207], v[76:79]
  v_exp_f32 v169, v169
  v_mfma_f32_16x16x32_bf16 v[88:91], a[184:187], v[200:203], v[88:91]
  v_exp_f32 v170, v170
  v_mfma_f32_16x16x32_bf16 v[88:91], a[216:219], v[204:207], v[88:91]
  v_exp_f32 v171, v171
  v_mfma_f32_16x16x32_bf16 v[92:95], a[188:191], v[200:203], v[92:95]
  v_exp_f32 v172, v172
  v_mfma_f32_16x16x32_bf16 v[92:95], a[220:223], v[204:207], v[92:95]
  v_exp_f32 v173, v173
  v_mfma_f32_16x16x32_bf16 v[176:179], a[32:35], v[224:227], v[240:243]
  v_exp_f32 v174, v174
  v_mfma_f32_16x16x32_bf16 v[176:179], a[40:43], v[228:231], v[176:179]
  v_exp_f32 v175, v175
  v_mfma_f32_16x16x32_bf16 v[176:179], a[48:51], v[232:235], v[176:179]
  ds_read_b64_tr_b16 a[194:195], v4 offset:17408
  v_cvt_pk_bf16_f32 v193, v162, v163
  v_mfma_f32_16x16x32_bf16 v[176:179], a[56:59], v[236:239], v[176:179]
  ds_read_b64_tr_b16 a[164:165], v4 offset:8200
  v_cvt_pk_bf16_f32 v194, v164, v165
  v_mfma_f32_16x16x32_bf16 v[180:183], a[60:63], v[236:239], v[240:243]
  ds_read_b64_tr_b16 a[166:167], v4 offset:9224
  v_cvt_pk_bf16_f32 v195, v166, v167
  v_mfma_f32_16x16x32_bf16 v[180:183], a[52:55], v[232:235], v[180:183]
  ds_read_b64_tr_b16 a[196:197], v4 offset:16392
  v_cvt_pk_bf16_f32 v196, v168, v169
  v_mfma_f32_16x16x32_bf16 v[180:183], a[44:47], v[228:231], v[180:183]
  ds_read_b64_tr_b16 a[198:199], v4 offset:17416
  v_cvt_pk_bf16_f32 v197, v170, v171
  v_mfma_f32_16x16x32_bf16 v[180:183], a[36:39], v[224:227], v[180:183]
  ds_read_b64_tr_b16 a[168:169], v4 offset:8448
  v_cvt_pk_bf16_f32 v198, v172, v173
  v_mfma_f32_16x16x32_bf16 v[188:191], a[4:7], v[224:227], v[240:243]
  ds_read_b64_tr_b16 a[170:171], v4 offset:9472
  v_cvt_pk_bf16_f32 v199, v174, v175
  v_mfma_f32_16x16x32_bf16 v[188:191], a[12:15], v[228:231], v[188:191]
  ds_read_b64_tr_b16 a[200:201], v4 offset:16640
  v_cvt_pk_bf16_f32 v120, v120, v121
  v_mfma_f32_16x16x32_bf16 v[188:191], a[20:23], v[232:235], v[188:191]
  ds_read_b64_tr_b16 a[202:203], v4 offset:17664
  v_cvt_pk_bf16_f32 v121, v122, v123
  v_mfma_f32_16x16x32_bf16 v[188:191], a[28:31], v[236:239], v[188:191]
  ds_read_b64_tr_b16 a[172:173], v4 offset:8456
  v_cvt_pk_bf16_f32 v122, v124, v125
  v_mfma_f32_16x16x32_bf16 v[184:187], a[24:27], v[236:239], v[240:243]
  ds_read_b64_tr_b16 a[174:175], v4 offset:9480
  v_cvt_pk_bf16_f32 v123, v126, v127
  v_mfma_f32_16x16x32_bf16 v[184:187], a[16:19], v[232:235], v[184:187]
  buffer_store_dwordx4 v[120:123], v1, s[20:23], s57 offen offset:64 sc1 nt
  v_exp_f32 v176, v176
  v_pk_mul_f32 v[136:137], v[136:137], v[22:23] op_sel_hi:[1,0]
  v_pk_mul_f32 v[138:139], v[138:139], v[22:23] op_sel_hi:[1,0]
  v_pk_mul_f32 v[140:141], v[140:141], v[22:23] op_sel_hi:[1,0]
  v_pk_mul_f32 v[142:143], v[142:143], v[22:23] op_sel_hi:[1,0]
  v_exp_f32 v177, v177
  v_mfma_f32_16x16x32_bf16 v[184:187], a[8:11], v[228:231], v[184:187]
  v_exp_f32 v178, v178
  v_mfma_f32_16x16x32_bf16 v[184:187], a[0:3], v[224:227], v[184:187]
  v_exp_f32 v179, v179
  v_mfma_f32_16x16x32_bf16 v[32:35], a[224:227], v[192:195], v[32:35]
  v_exp_f32 v180, v180
  v_mfma_f32_16x16x32_bf16 v[32:35], a[128:131], v[196:199], v[32:35]
  v_exp_f32 v181, v181
  v_mfma_f32_16x16x32_bf16 v[36:39], a[228:231], v[192:195], v[36:39]
  v_exp_f32 v182, v182
  v_mfma_f32_16x16x32_bf16 v[36:39], a[132:135], v[196:199], v[36:39]
  v_exp_f32 v183, v183
  v_smfmac_f32_16x16x64_bf16 v[24:27], v[10:13], v[192:199], v0
  v_cvt_pk_bf16_f32 v200, v176, v177
  v_mfma_f32_16x16x32_bf16 v[48:51], a[232:235], v[192:195], v[48:51]
  v_exp_f32 v184, v184
  v_mfma_f32_16x16x32_bf16 v[48:51], a[136:139], v[196:199], v[48:51]
  v_exp_f32 v185, v185
  v_mfma_f32_16x16x32_bf16 v[52:55], a[236:239], v[192:195], v[52:55]
  v_exp_f32 v186, v186
  v_mfma_f32_16x16x32_bf16 v[52:55], a[140:143], v[196:199], v[52:55]
  v_exp_f32 v187, v187
  v_mfma_f32_16x16x32_bf16 v[64:67], a[240:243], v[192:195], v[64:67]
  v_exp_f32 v188, v188
  v_mfma_f32_16x16x32_bf16 v[64:67], a[144:147], v[196:199], v[64:67]
  v_exp_f32 v189, v189
  v_mfma_f32_16x16x32_bf16 v[68:71], a[244:247], v[192:195], v[68:71]
  v_exp_f32 v190, v190
  v_mfma_f32_16x16x32_bf16 v[68:71], a[148:151], v[196:199], v[68:71]
  v_exp_f32 v191, v191
  v_mfma_f32_16x16x32_bf16 v[80:83], a[248:251], v[192:195], v[80:83]
  ds_read_b64_tr_b16 a[204:205], v4 offset:16648
  v_cvt_pk_bf16_f32 v201, v178, v179
  v_mfma_f32_16x16x32_bf16 v[80:83], a[152:155], v[196:199], v[80:83]
  ds_read_b64_tr_b16 a[206:207], v4 offset:17672
  v_cvt_pk_bf16_f32 v202, v180, v181
  v_mfma_f32_16x16x32_bf16 v[84:87], a[252:255], v[192:195], v[84:87]
  ds_read_b64_tr_b16 a[176:177], v4 offset:8704
  v_cvt_pk_bf16_f32 v203, v182, v183
  v_mfma_f32_16x16x32_bf16 v[84:87], a[156:159], v[196:199], v[84:87]
  ds_read_b64_tr_b16 a[178:179], v4 offset:9728
  v_cvt_pk_bf16_f32 v204, v184, v185
  v_mfma_f32_16x16x32_bf16 v[160:163], a[64:67], v[208:211], v[240:243]
  ds_read_b64_tr_b16 a[208:209], v4 offset:16896
  v_cvt_pk_bf16_f32 v205, v186, v187
  v_mfma_f32_16x16x32_bf16 v[160:163], a[72:75], v[212:215], v[160:163]
  ds_read_b64_tr_b16 a[210:211], v4 offset:17920
  v_cvt_pk_bf16_f32 v206, v188, v189
  v_mfma_f32_16x16x32_bf16 v[160:163], a[80:83], v[216:219], v[160:163]
  ds_read_b64_tr_b16 a[180:181], v4 offset:8712
  v_cvt_pk_bf16_f32 v207, v190, v191
  v_mfma_f32_16x16x32_bf16 v[160:163], a[88:91], v[220:223], v[160:163]
  ds_read_b64_tr_b16 a[182:183], v4 offset:9736
  v_cvt_pk_bf16_f32 v128, v128, v129
  v_mfma_f32_16x16x32_bf16 v[164:167], a[92:95], v[220:223], v[240:243]
  ds_read_b64_tr_b16 a[212:213], v4 offset:16904
  v_cvt_pk_bf16_f32 v129, v130, v131
  v_mfma_f32_16x16x32_bf16 v[164:167], a[84:87], v[216:219], v[164:167]
  ds_read_b64_tr_b16 a[214:215], v4 offset:17928
  v_cvt_pk_bf16_f32 v130, v132, v133
  v_mfma_f32_16x16x32_bf16 v[164:167], a[76:79], v[212:215], v[164:167]
  ds_read_b64_tr_b16 a[184:185], v4 offset:8960
  v_cvt_pk_bf16_f32 v131, v134, v135
  v_mfma_f32_16x16x32_bf16 v[164:167], a[68:71], v[208:211], v[164:167]
  buffer_store_dwordx4 v[128:131], v1, s[20:23], s29 offen offset:128 sc1 nt
  v_exp_f32 v160, v160
  v_pk_mul_f32 v[144:145], v[144:145], v[20:21] op_sel_hi:[1,0]
  v_pk_mul_f32 v[146:147], v[146:147], v[20:21] op_sel_hi:[1,0]
  v_pk_mul_f32 v[148:149], v[148:149], v[20:21] op_sel_hi:[1,0]
  v_pk_mul_f32 v[150:151], v[150:151], v[20:21] op_sel_hi:[1,0]
  v_exp_f32 v161, v161
  v_mfma_f32_16x16x32_bf16 v[172:175], a[100:103], v[208:211], v[240:243]
  v_exp_f32 v162, v162
  v_mfma_f32_16x16x32_bf16 v[172:175], a[108:111], v[212:215], v[172:175]
  v_exp_f32 v163, v163
  v_mfma_f32_16x16x32_bf16 v[172:175], a[116:119], v[216:219], v[172:175]
  v_exp_f32 v164, v164
  v_mfma_f32_16x16x32_bf16 v[172:175], a[124:127], v[220:223], v[172:175]
  v_exp_f32 v165, v165
  v_mfma_f32_16x16x32_bf16 v[168:171], a[120:123], v[220:223], v[240:243]
  v_exp_f32 v166, v166
  v_mfma_f32_16x16x32_bf16 v[168:171], a[112:115], v[216:219], v[168:171]
  v_exp_f32 v167, v167
  v_mfma_f32_16x16x32_bf16 v[168:171], a[104:107], v[212:215], v[168:171]
  v_exp_f32 v172, v172
  v_mfma_f32_16x16x32_bf16 v[168:171], a[96:99], v[208:211], v[168:171]
  v_exp_f32 v173, v173
  v_mfma_f32_16x16x32_bf16 v[40:43], a[224:227], v[200:203], v[40:43]
  v_exp_f32 v174, v174
  v_mfma_f32_16x16x32_bf16 v[40:43], a[128:131], v[204:207], v[40:43]
  v_exp_f32 v175, v175
  v_mfma_f32_16x16x32_bf16 v[44:47], a[228:231], v[200:203], v[44:47]
  v_exp_f32 v168, v168
  v_mfma_f32_16x16x32_bf16 v[44:47], a[132:135], v[204:207], v[44:47]
  v_exp_f32 v169, v169
  v_smfmac_f32_16x16x64_bf16 v[28:31], v[10:13], v[200:207], v0
  v_cvt_pk_bf16_f32 v192, v160, v161
  v_mfma_f32_16x16x32_bf16 v[56:59], a[232:235], v[200:203], v[56:59]
  v_exp_f32 v170, v170
  v_mfma_f32_16x16x32_bf16 v[56:59], a[136:139], v[204:207], v[56:59]
  v_exp_f32 v171, v171
  v_mfma_f32_16x16x32_bf16 v[60:63], a[236:239], v[200:203], v[60:63]
  ds_read_b64_tr_b16 a[186:187], v4 offset:9984
  v_cvt_pk_bf16_f32 v193, v162, v163
  v_mfma_f32_16x16x32_bf16 v[60:63], a[140:143], v[204:207], v[60:63]
  ds_read_b64_tr_b16 a[216:217], v4 offset:17152
  v_cvt_pk_bf16_f32 v194, v164, v165
  v_mfma_f32_16x16x32_bf16 v[72:75], a[240:243], v[200:203], v[72:75]
  ds_read_b64_tr_b16 a[218:219], v4 offset:18176
  v_cvt_pk_bf16_f32 v195, v166, v167
  v_mfma_f32_16x16x32_bf16 v[72:75], a[144:147], v[204:207], v[72:75]
  ds_read_b64_tr_b16 a[188:189], v4 offset:8968
  v_cvt_pk_bf16_f32 v196, v168, v169
  v_mfma_f32_16x16x32_bf16 v[76:79], a[244:247], v[200:203], v[76:79]
  ds_read_b64_tr_b16 a[190:191], v4 offset:9992
  v_cvt_pk_bf16_f32 v197, v170, v171
  v_mfma_f32_16x16x32_bf16 v[76:79], a[148:151], v[204:207], v[76:79]
  ds_read_b64_tr_b16 a[220:221], v4 offset:17160
  v_cvt_pk_bf16_f32 v198, v172, v173
  v_mfma_f32_16x16x32_bf16 v[88:91], a[248:251], v[200:203], v[88:91]
  ds_read_b64_tr_b16 a[222:223], v4 offset:18184
  v_cvt_pk_bf16_f32 v199, v174, v175
  v_mfma_f32_16x16x32_bf16 v[88:91], a[152:155], v[204:207], v[88:91]
  ds_read_b128 a[32:35], v2 offset:57344
  ds_read_b128 a[40:43], v2 offset:57600
  v_mfma_f32_16x16x32_bf16 v[92:95], a[252:255], v[200:203], v[92:95]
  ds_read_b128 a[48:51], v2 offset:57856
  ds_read_b128 a[56:59], v2 offset:58112
  v_mfma_f32_16x16x32_bf16 v[92:95], a[156:159], v[204:207], v[92:95]
  ds_read_b128 a[60:63], v2 offset:59136
  ds_read_b128 a[52:55], v2 offset:58880
  v_mfma_f32_16x16x32_bf16 v[176:179], a[64:67], v[224:227], v[240:243]
  ds_read_b128 a[44:47], v2 offset:58624
  ds_read_b128 a[36:39], v2 offset:58368
  v_mfma_f32_16x16x32_bf16 v[176:179], a[72:75], v[228:231], v[176:179]
  ds_read_b128 a[4:7], v3 offset:1024
  ds_read_b128 a[12:15], v3 offset:1280
  v_mfma_f32_16x16x32_bf16 v[176:179], a[80:83], v[232:235], v[176:179]
  ds_read_b128 a[20:23], v3 offset:1536
  ds_read_b128 a[28:31], v3 offset:1792
  v_mfma_f32_16x16x32_bf16 v[176:179], a[88:91], v[236:239], v[176:179]
  ds_read_b128 a[24:27], v3 offset:768
  ds_read_b128 a[16:19], v3 offset:512
  v_mfma_f32_16x16x32_bf16 v[180:183], a[92:95], v[236:239], v[240:243]
  ds_read_b128 a[8:11], v3 offset:256
  v_cvt_pk_bf16_f32 v136, v136, v137
  v_mfma_f32_16x16x32_bf16 v[180:183], a[84:87], v[232:235], v[180:183]
  ds_read_b128 a[0:3], v3 offset:0
  v_cvt_pk_bf16_f32 v137, v138, v139
  v_mfma_f32_16x16x32_bf16 v[180:183], a[76:79], v[228:231], v[180:183]
  ds_read_b128 a[224:227], v3 offset:8192
  v_cvt_pk_bf16_f32 v138, v140, v141
  v_mfma_f32_16x16x32_bf16 v[180:183], a[68:71], v[224:227], v[180:183]
  ds_read_b128 a[232:235], v3 offset:8448
  v_cvt_pk_bf16_f32 v139, v142, v143
  v_mfma_f32_16x16x32_bf16 v[188:191], a[100:103], v[224:227], v[240:243]
  buffer_store_dwordx4 v[136:139], v1, s[20:23], s57 offen offset:128 sc1 nt
  v_exp_f32 v176, v176
  v_pk_mul_f32 v[152:153], v[152:153], v[22:23] op_sel_hi:[1,0]
  v_pk_mul_f32 v[154:155], v[154:155], v[22:23] op_sel_hi:[1,0]
  v_pk_mul_f32 v[156:157], v[156:157], v[22:23] op_sel_hi:[1,0]
  v_pk_mul_f32 v[158:159], v[158:159], v[22:23] op_sel_hi:[1,0]
  v_exp_f32 v177, v177
  v_mfma_f32_16x16x32_bf16 v[188:191], a[108:111], v[228:231], v[188:191]
  v_exp_f32 v178, v178
  v_mfma_f32_16x16x32_bf16 v[188:191], a[116:119], v[232:235], v[188:191]
  v_exp_f32 v179, v179
  v_mfma_f32_16x16x32_bf16 v[188:191], a[124:127], v[236:239], v[188:191]
  v_exp_f32 v180, v180
  v_mfma_f32_16x16x32_bf16 v[184:187], a[120:123], v[236:239], v[240:243]
  v_exp_f32 v181, v181
  v_mfma_f32_16x16x32_bf16 v[184:187], a[112:115], v[232:235], v[184:187]
  v_exp_f32 v182, v182
  v_mfma_f32_16x16x32_bf16 v[184:187], a[104:107], v[228:231], v[184:187]
  v_exp_f32 v183, v183
  v_mfma_f32_16x16x32_bf16 v[184:187], a[96:99], v[224:227], v[184:187]
  s_waitcnt lgkmcnt(0)
  v_exp_f32 v188, v188
  v_mfma_f32_16x16x32_bf16 v[32:35], a[160:163], v[192:195], v[32:35]
  v_exp_f32 v189, v189
  v_mfma_f32_16x16x32_bf16 v[32:35], a[192:195], v[196:199], v[32:35]
  v_exp_f32 v190, v190
  v_mfma_f32_16x16x32_bf16 v[36:39], a[164:167], v[192:195], v[36:39]
  v_exp_f32 v184, v184
  v_mfma_f32_16x16x32_bf16 v[36:39], a[196:199], v[196:199], v[36:39]
  v_exp_f32 v185, v185
  v_smfmac_f32_16x16x64_bf16 v[24:27], v[10:13], v[192:199], v0
  v_cvt_pk_bf16_f32 v200, v176, v177
  v_mfma_f32_16x16x32_bf16 v[48:51], a[168:171], v[192:195], v[48:51]
  v_exp_f32 v186, v186
  v_mfma_f32_16x16x32_bf16 v[48:51], a[200:203], v[196:199], v[48:51]
  v_exp_f32 v187, v187
  v_mfma_f32_16x16x32_bf16 v[52:55], a[172:175], v[192:195], v[52:55]
  v_exp_f32 v191, v191
  v_mfma_f32_16x16x32_bf16 v[52:55], a[204:207], v[196:199], v[52:55]
  ds_read_b128 a[240:243], v3 offset:8704
  v_cvt_pk_bf16_f32 v201, v178, v179
  v_mfma_f32_16x16x32_bf16 v[64:67], a[176:179], v[192:195], v[64:67]
  ds_read_b128 a[248:251], v3 offset:8960
  v_cvt_pk_bf16_f32 v202, v180, v181
  v_mfma_f32_16x16x32_bf16 v[64:67], a[208:211], v[196:199], v[64:67]
  ds_read_b128 a[252:255], v3 offset:9984
  v_cvt_pk_bf16_f32 v203, v182, v183
  v_mfma_f32_16x16x32_bf16 v[68:71], a[180:183], v[192:195], v[68:71]
  ds_read_b128 a[244:247], v3 offset:9728
  v_cvt_pk_bf16_f32 v204, v184, v185
  v_mfma_f32_16x16x32_bf16 v[68:71], a[212:215], v[196:199], v[68:71]
  ds_read_b128 a[236:239], v3 offset:9472
  v_cvt_pk_bf16_f32 v205, v186, v187
  v_mfma_f32_16x16x32_bf16 v[80:83], a[184:187], v[192:195], v[80:83]
  ds_read_b128 a[228:231], v3 offset:9216
  v_cvt_pk_bf16_f32 v206, v188, v189
  v_mfma_f32_16x16x32_bf16 v[80:83], a[216:219], v[196:199], v[80:83]
  ds_read_b128 a[132:135], v3 offset:17408
  v_cvt_pk_bf16_f32 v207, v190, v191
  v_mfma_f32_16x16x32_bf16 v[84:87], a[188:191], v[192:195], v[84:87]
  ds_read_b128 a[140:143], v3 offset:17664
  ds_read_b128 a[148:151], v3 offset:17920
  v_mfma_f32_16x16x32_bf16 v[84:87], a[220:223], v[196:199], v[84:87]
  ds_read_b128 a[156:159], v3 offset:18176
  v_cvt_pk_bf16_f32 v144, v144, v145
  v_mfma_f32_16x16x32_bf16 v[160:163], a[32:35], v[208:211], v[240:243]
  ds_read_b128 a[152:155], v3 offset:17152
  v_cvt_pk_bf16_f32 v145, v146, v147
  v_mfma_f32_16x16x32_bf16 v[160:163], a[40:43], v[212:215], v[160:163]
  ds_read_b128 a[144:147], v3 offset:16896
  v_cvt_pk_bf16_f32 v146, v148, v149
  v_mfma_f32_16x16x32_bf16 v[160:163], a[48:51], v[216:219], v[160:163]
  ds_read_b128 a[136:139], v3 offset:16640
  v_cvt_pk_bf16_f32 v147, v150, v151
  v_mfma_f32_16x16x32_bf16 v[160:163], a[56:59], v[220:223], v[160:163]
  buffer_store_dwordx4 v[144:147], v1, s[20:23], s29 offen offset:192 sc1 nt
  ds_read_b128 a[128:131], v3 offset:16384
  ds_read_b64_tr_b16 a[64:65], v4 offset:24576
  ds_read_b64_tr_b16 a[66:67], v4 offset:25600
  ds_read_b64_tr_b16 a[96:97], v4 offset:32768
  v_mfma_f32_16x16x32_bf16 v[164:167], a[60:63], v[220:223], v[240:243]
  ds_read_b64_tr_b16 a[98:99], v4 offset:33792
  ds_read_b64_tr_b16 a[68:69], v4 offset:24584
  v_mfma_f32_16x16x32_bf16 v[164:167], a[52:55], v[216:219], v[164:167]
  ds_read_b64_tr_b16 a[70:71], v4 offset:25608
  ds_read_b64_tr_b16 a[100:101], v4 offset:32776
  v_mfma_f32_16x16x32_bf16 v[164:167], a[44:47], v[212:215], v[164:167]
  ds_read_b64_tr_b16 a[102:103], v4 offset:33800
  ds_read_b64_tr_b16 a[72:73], v4 offset:24832
  v_mfma_f32_16x16x32_bf16 v[164:167], a[36:39], v[208:211], v[164:167]
  ds_read_b64_tr_b16 a[74:75], v4 offset:25856
  ds_read_b64_tr_b16 a[104:105], v4 offset:33024
  v_mfma_f32_16x16x32_bf16 v[172:175], a[4:7], v[208:211], v[240:243]
  ds_read_b64_tr_b16 a[106:107], v4 offset:34048
  ds_read_b64_tr_b16 a[76:77], v4 offset:24840
  v_mfma_f32_16x16x32_bf16 v[172:175], a[12:15], v[212:215], v[172:175]
  v_exp_f32 v160, v160
  v_mfma_f32_16x16x32_bf16 v[172:175], a[20:23], v[216:219], v[172:175]
  v_exp_f32 v161, v161
  v_mfma_f32_16x16x32_bf16 v[172:175], a[28:31], v[220:223], v[172:175]
  v_exp_f32 v162, v162
  v_mfma_f32_16x16x32_bf16 v[168:171], a[24:27], v[220:223], v[240:243]
  v_exp_f32 v163, v163
  v_mfma_f32_16x16x32_bf16 v[168:171], a[16:19], v[216:219], v[168:171]
  v_exp_f32 v164, v164
  v_mfma_f32_16x16x32_bf16 v[168:171], a[8:11], v[212:215], v[168:171]
  v_exp_f32 v165, v165
  v_mfma_f32_16x16x32_bf16 v[168:171], a[0:3], v[208:211], v[168:171]
  v_exp_f32 v166, v166
  v_mfma_f32_16x16x32_bf16 v[40:43], a[160:163], v[200:203], v[40:43]
  v_exp_f32 v167, v167
  v_mfma_f32_16x16x32_bf16 v[40:43], a[192:195], v[204:207], v[40:43]
  ds_read_b64_tr_b16 a[78:79], v4 offset:25864
  ds_read_b64_tr_b16 a[108:109], v4 offset:33032
  v_mfma_f32_16x16x32_bf16 v[44:47], a[164:167], v[200:203], v[44:47]
  v_exp_f32 v168, v168
  v_mfma_f32_16x16x32_bf16 v[44:47], a[196:199], v[204:207], v[44:47]
  v_exp_f32 v169, v169
  v_smfmac_f32_16x16x64_bf16 v[28:31], v[10:13], v[200:207], v0
  ds_read_b64_tr_b16 a[110:111], v4 offset:34056
  v_mfma_f32_16x16x32_bf16 v[56:59], a[168:171], v[200:203], v[56:59]
  v_exp_f32 v170, v170
  v_mfma_f32_16x16x32_bf16 v[56:59], a[200:203], v[204:207], v[56:59]
  v_exp_f32 v171, v171
  v_mfma_f32_16x16x32_bf16 v[60:63], a[172:175], v[200:203], v[60:63]
  v_exp_f32 v172, v172
  v_mfma_f32_16x16x32_bf16 v[60:63], a[204:207], v[204:207], v[60:63]
  v_exp_f32 v173, v173
  v_mfma_f32_16x16x32_bf16 v[72:75], a[176:179], v[200:203], v[72:75]
  v_exp_f32 v174, v174
  v_mfma_f32_16x16x32_bf16 v[72:75], a[208:211], v[204:207], v[72:75]
  v_exp_f32 v175, v175
  v_mfma_f32_16x16x32_bf16 v[76:79], a[180:183], v[200:203], v[76:79]
  ds_read_b64_tr_b16 a[80:81], v4 offset:25088
  v_cvt_pk_bf16_f32 v192, v160, v161
  v_mfma_f32_16x16x32_bf16 v[76:79], a[212:215], v[204:207], v[76:79]
  ds_read_b64_tr_b16 a[82:83], v4 offset:26112
  v_cvt_pk_bf16_f32 v193, v162, v163
  v_mfma_f32_16x16x32_bf16 v[88:91], a[184:187], v[200:203], v[88:91]
  ds_read_b64_tr_b16 a[112:113], v4 offset:33280
  v_cvt_pk_bf16_f32 v194, v164, v165
  v_mfma_f32_16x16x32_bf16 v[88:91], a[216:219], v[204:207], v[88:91]
  ds_read_b64_tr_b16 a[114:115], v4 offset:34304
  v_cvt_pk_bf16_f32 v195, v166, v167
  v_mfma_f32_16x16x32_bf16 v[92:95], a[188:191], v[200:203], v[92:95]
  ds_read_b64_tr_b16 a[84:85], v4 offset:25096
  v_cvt_pk_bf16_f32 v196, v168, v169
  v_mfma_f32_16x16x32_bf16 v[92:95], a[220:223], v[204:207], v[92:95]
  ds_read_b64_tr_b16 a[86:87], v4 offset:26120
  v_cvt_pk_bf16_f32 v197, v170, v171
  v_mfma_f32_16x16x32_bf16 v[176:179], a[224:227], v[208:211], v[240:243]
  ds_read_b64_tr_b16 a[116:117], v4 offset:33288
  v_cvt_pk_bf16_f32 v198, v172, v173
  v_mfma_f32_16x16x32_bf16 v[176:179], a[232:235], v[212:215], v[176:179]
  s_waitcnt lgkmcnt(5)
  ds_read_b64_tr_b16 a[118:119], v4 offset:34312
  v_cvt_pk_bf16_f32 v199, v174, v175
  v_mfma_f32_16x16x32_bf16 v[176:179], a[240:243], v[216:219], v[176:179]
L_t5:
  s_cbranch_vccnz L_back
  ds_read_b64_tr_b16 a[88:89], v4 offset:25344
  ds_read_b64_tr_b16 a[90:91], v4 offset:26368
  v_mfma_f32_16x16x32_bf16 v[176:179], a[248:251], v[220:223], v[176:179]
  ds_read_b64_tr_b16 a[120:121], v4 offset:33536
  ds_read_b64_tr_b16 a[122:123], v4 offset:34560
  v_mfma_f32_16x16x32_bf16 v[180:183], a[252:255], v[220:223], v[240:243]
  ds_read_b64_tr_b16 a[92:93], v4 offset:25352
  ds_read_b64_tr_b16 a[94:95], v4 offset:26376
  v_mfma_f32_16x16x32_bf16 v[180:183], a[244:247], v[216:219], v[180:183]
  ds_read_b64_tr_b16 a[124:125], v4 offset:33544
  ds_read_b64_tr_b16 a[126:127], v4 offset:34568
  v_mfma_f32_16x16x32_bf16 v[180:183], a[236:239], v[212:215], v[180:183]
  ds_read_b64_tr_b16 a[160:161], v4 offset:40960
  v_cvt_pk_bf16_f32 v152, v152, v153
  v_mfma_f32_16x16x32_bf16 v[180:183], a[228:231], v[208:211], v[180:183]
  ds_read_b64_tr_b16 a[162:163], v4 offset:41984
  v_cvt_pk_bf16_f32 v153, v154, v155
  v_mfma_f32_16x16x32_bf16 v[188:191], a[132:135], v[208:211], v[240:243]
  ds_read_b64_tr_b16 a[192:193], v4 offset:49152
  v_cvt_pk_bf16_f32 v154, v156, v157
  v_mfma_f32_16x16x32_bf16 v[188:191], a[140:143], v[212:215], v[188:191]
  ds_read_b64_tr_b16 a[194:195], v4 offset:50176
  v_cvt_pk_bf16_f32 v155, v158, v159
  v_mfma_f32_16x16x32_bf16 v[188:191], a[148:151], v[216:219], v[188:191]
  buffer_store_dwordx4 v[152:155], v1, s[20:23], s57 offen offset:192 sc1 nt
  ds_read_b64_tr_b16 a[164:165], v4 offset:40968
  ds_read_b64_tr_b16 a[166:167], v4 offset:41992
  ds_read_b64_tr_b16 a[196:197], v4 offset:49160
  ds_read_b64_tr_b16 a[198:199], v4 offset:50184
  v_mfma_f32_16x16x32_bf16 v[188:191], a[156:159], v[220:223], v[188:191]
  ds_read_b64_tr_b16 a[168:169], v4 offset:41216
  ds_read_b64_tr_b16 a[170:171], v4 offset:42240
  v_mfma_f32_16x16x32_bf16 v[184:187], a[152:155], v[220:223], v[240:243]
  ds_read_b64_tr_b16 a[200:201], v4 offset:49408
  ds_read_b64_tr_b16 a[202:203], v4 offset:50432
  v_mfma_f32_16x16x32_bf16 v[184:187], a[144:147], v[216:219], v[184:187]
  v_exp_f32 v176, v176
  v_mfma_f32_16x16x32_bf16 v[184:187], a[136:139], v[212:215], v[184:187]
  v_exp_f32 v177, v177
  v_mfma_f32_16x16x32_bf16 v[184:187], a[128:131], v[208:211], v[184:187]
  v_exp_f32 v178, v178
  v_mfma_f32_16x16x32_bf16 v[32:35], a[64:67], v[192:195], v[32:35]
  v_exp_f32 v179, v179
  v_mfma_f32_16x16x32_bf16 v[32:35], a[96:99], v[196:199], v[32:35]
  v_exp_f32 v180, v180
  v_mfma_f32_16x16x32_bf16 v[36:39], a[68:71], v[192:195], v[36:39]
  v_exp_f32 v181, v181
  v_mfma_f32_16x16x32_bf16 v[36:39], a[100:103], v[196:199], v[36:39]
  v_exp_f32 v182, v182
  v_smfmac_f32_16x16x64_bf16 v[24:27], v[10:13], v[192:199], v0
  ds_read_b64_tr_b16 a[172:173], v4 offset:41224
  v_mfma_f32_16x16x32_bf16 v[48:51], a[72:75], v[192:195], v[48:51]
  v_exp_f32 v183, v183
  v_mfma_f32_16x16x32_bf16 v[48:51], a[104:107], v[196:199], v[48:51]
  ds_read_b64_tr_b16 a[174:175], v4 offset:42248
  ds_read_b64_tr_b16 a[204:205], v4 offset:49416
  v_mfma_f32_16x16x32_bf16 v[52:55], a[76:79], v[192:195], v[52:55]
  v_exp_f32 v184, v184
  v_mfma_f32_16x16x32_bf16 v[52:55], a[108:111], v[196:199], v[52:55]
  v_exp_f32 v185, v185
  v_mfma_f32_16x16x32_bf16 v[64:67], a[80:83], v[192:195], v[64:67]
  s_waitcnt lgkmcnt(3)
  v_exp_f32 v186, v186
  v_mfma_f32_16x16x32_bf16 v[64:67], a[112:115], v[196:199], v[64:67]
  v_exp_f32 v187, v187
  v_mfma_f32_16x16x32_bf16 v[68:71], a[84:87], v[192:195], v[68:71]
  v_exp_f32 v188, v188
  v_mfma_f32_16x16x32_bf16 v[68:71], a[116:119], v[196:199], v[68:71]
  v_exp_f32 v189, v189
  v_mfma_f32_16x16x32_bf16 v[80:83], a[88:91], v[192:195], v[80:83]
  v_exp_f32 v190, v190
  v_mfma_f32_16x16x32_bf16 v[80:83], a[120:123], v[196:199], v[80:83]
  v_exp_f32 v191, v191
  v_mfma_f32_16x16x32_bf16 v[84:87], a[92:95], v[192:195], v[84:87]
  ds_read_b64_tr_b16 a[206:207], v4 offset:50440
  v_cvt_pk_bf16_f32 v200, v176, v177
  v_mfma_f32_16x16x32_bf16 v[84:87], a[124:127], v[196:199], v[84:87]
  ds_read_b64_tr_b16 a[176:177], v4 offset:41472
  v_cvt_pk_bf16_f32 v201, v178, v179
  v_mfma_f32_16x16x32_bf16 v[160:163], a[224:227], v[224:227], v[240:243]
  ds_read_b64_tr_b16 a[178:179], v4 offset:42496
  v_cvt_pk_bf16_f32 v202, v180, v181
  v_mfma_f32_16x16x32_bf16 v[160:163], a[232:235], v[228:231], v[160:163]
  ds_read_b64_tr_b16 a[208:209], v4 offset:49664
  v_cvt_pk_bf16_f32 v203, v182, v183
  v_mfma_f32_16x16x32_bf16 v[160:163], a[240:243], v[232:235], v[160:163]
  ds_read_b64_tr_b16 a[210:211], v4 offset:50688
  v_cvt_pk_bf16_f32 v204, v184, v185
  v_mfma_f32_16x16x32_bf16 v[160:163], a[248:251], v[236:239], v[160:163]
  ds_read_b64_tr_b16 a[180:181], v4 offset:41480
  v_cvt_pk_bf16_f32 v205, v186, v187
  v_mfma_f32_16x16x32_bf16 v[164:167], a[252:255], v[236:239], v[240:243]
  ds_read_b64_tr_b16 a[182:183], v4 offset:42504
  v_cvt_pk_bf16_f32 v206, v188, v189
  v_mfma_f32_16x16x32_bf16 v[164:167], a[244:247], v[232:235], v[164:167]
  ds_read_b64_tr_b16 a[212:213], v4 offset:49672
  v_cvt_pk_bf16_f32 v207, v190, v191
  v_mfma_f32_16x16x32_bf16 v[164:167], a[236:239], v[228:231], v[164:167]
  ds_read_b64_tr_b16 a[214:215], v4 offset:50696
  ds_read_b64_tr_b16 a[184:185], v4 offset:41728
  v_mfma_f32_16x16x32_bf16 v[164:167], a[228:231], v[224:227], v[164:167]
  ds_read_b64_tr_b16 a[186:187], v4 offset:42752
  ds_read_b64_tr_b16 a[216:217], v4 offset:49920
  v_mfma_f32_16x16x32_bf16 v[172:175], a[132:135], v[224:227], v[240:243]
  ds_read_b64_tr_b16 a[218:219], v4 offset:50944
  ds_read_b64_tr_b16 a[188:189], v4 offset:41736
  v_mfma_f32_16x16x32_bf16 v[172:175], a[140:143], v[228:231], v[172:175]
  ds_read_b64_tr_b16 a[190:191], v4 offset:42760
  ds_read_b64_tr_b16 a[220:221], v4 offset:49928
  v_mfma_f32_16x16x32_bf16 v[172:175], a[148:151], v[232:235], v[172:175]
  ds_read_b64_tr_b16 a[222:223], v4 offset:50952
  v_add_f32 v15, v14, v15
  v_mfma_f32_16x16x32_bf16 v[172:175], a[156:159], v[236:239], v[172:175]
  v_exp_f32 v160, v160
  v_mfma_f32_16x16x32_bf16 v[168:171], a[152:155], v[236:239], v[240:243]
  v_exp_f32 v161, v161
  v_mfma_f32_16x16x32_bf16 v[168:171], a[144:147], v[232:235], v[168:171]
  v_exp_f32 v162, v162
  v_mfma_f32_16x16x32_bf16 v[168:171], a[136:139], v[228:231], v[168:171]
  v_exp_f32 v163, v163
  v_mfma_f32_16x16x32_bf16 v[168:171], a[128:131], v[224:227], v[168:171]
  v_exp_f32 v164, v164
  v_mfma_f32_16x16x32_bf16 v[32:35], a[160:163], v[200:203], v[32:35]
  v_exp_f32 v165, v165
  v_mfma_f32_16x16x32_bf16 v[32:35], a[192:195], v[204:207], v[32:35]
  v_exp_f32 v166, v166
  v_smfmac_f32_16x16x64_bf16 v[24:27], v[10:13], v[200:207], v0
  v_cvt_pk_bf16_f32 v192, v160, v161
  v_mfma_f32_16x16x32_bf16 v[36:39], a[164:167], v[200:203], v[36:39]
  v_exp_f32 v167, v167
  v_mfma_f32_16x16x32_bf16 v[36:39], a[196:199], v[204:207], v[36:39]
  v_exp_f32 v168, v168
  v_mfma_f32_16x16x32_bf16 v[48:51], a[168:171], v[200:203], v[48:51]
  v_add_f32 v27, v26, v27
  v_add_f32 v24, v24, v25
  v_mfma_f32_16x16x32_bf16 v[48:51], a[200:203], v[204:207], v[48:51]
  s_waitcnt lgkmcnt(0)
  v_add_f32 v27, v27, v24
  v_cvt_pk_bf16_f32 v193, v162, v163
  v_mfma_f32_16x16x32_bf16 v[52:55], a[172:175], v[200:203], v[52:55]
  v_rcp_f32 v26, v27
  v_mfma_f32_16x16x32_bf16 v[52:55], a[204:207], v[204:207], v[52:55]
  v_mul_f32 v32, v26, v32
  v_mul_f32 v33, v26, v33
  v_mfma_f32_16x16x32_bf16 v[64:67], a[176:179], v[200:203], v[64:67]
  v_cvt_pk_bf16_f32 v32, v32, v33
  v_mul_f32 v34, v26, v34
  v_mfma_f32_16x16x32_bf16 v[64:67], a[208:211], v[204:207], v[64:67]
  v_mul_f32 v35, v26, v35
  v_cvt_pk_bf16_f32 v33, v34, v35
  v_mfma_f32_16x16x32_bf16 v[68:71], a[180:183], v[200:203], v[68:71]
  v_mul_f32 v36, v26, v36
  v_mul_f32 v37, v26, v37
  v_mfma_f32_16x16x32_bf16 v[68:71], a[212:215], v[204:207], v[68:71]
  v_cvt_pk_bf16_f32 v34, v36, v37
  v_mul_f32 v38, v26, v38
  v_mfma_f32_16x16x32_bf16 v[80:83], a[184:187], v[200:203], v[80:83]
  v_mul_f32 v39, v26, v39
  v_cvt_pk_bf16_f32 v35, v38, v39
  v_mfma_f32_16x16x32_bf16 v[80:83], a[216:219], v[204:207], v[80:83]
  buffer_store_dwordx4 v[32:35], v1, s[20:23], s30 offen offset:0 sc1 nt
  v_mul_f32 v48, v26, v48
  v_mul_f32 v49, v26, v49
  v_cvt_pk_bf16_f32 v48, v48, v49
  v_pk_mul_f32 v[52:53], v[52:53], v[26:27] op_sel_hi:[1,0]
  v_pk_mul_f32 v[54:55], v[54:55], v[26:27] op_sel_hi:[1,0]
  v_pk_mul_f32 v[64:65], v[64:65], v[26:27] op_sel_hi:[1,0]
  v_pk_mul_f32 v[66:67], v[66:67], v[26:27] op_sel_hi:[1,0]
  v_mul_f32 v50, v26, v50
  v_mfma_f32_16x16x32_bf16 v[84:87], a[188:191], v[200:203], v[84:87]
  v_mul_f32 v51, v26, v51
  v_cvt_pk_bf16_f32 v49, v50, v51
  v_mfma_f32_16x16x32_bf16 v[84:87], a[220:223], v[204:207], v[84:87]
  v_cvt_pk_bf16_f32 v50, v52, v53
  v_cvt_pk_bf16_f32 v51, v54, v55
  v_mfma_f32_16x16x32_bf16 v[176:179], a[32:35], v[224:227], v[240:243]
  buffer_store_dwordx4 v[48:51], v1, s[20:23], s30 offen offset:64 sc1 nt
  v_exp_f32 v169, v169
  v_pk_mul_f32 v[68:69], v[68:69], v[26:27] op_sel_hi:[1,0]
  v_pk_mul_f32 v[70:71], v[70:71], v[26:27] op_sel_hi:[1,0]
  v_pk_mul_f32 v[80:81], v[80:81], v[26:27] op_sel_hi:[1,0]
  v_pk_mul_f32 v[82:83], v[82:83], v[26:27] op_sel_hi:[1,0]
  v_exp_f32 v170, v170
  v_mfma_f32_16x16x32_bf16 v[176:179], a[40:43], v[228:231], v[176:179]
  v_exp_f32 v171, v171
  v_mfma_f32_16x16x32_bf16 v[176:179], a[48:51], v[232:235], v[176:179]
  v_exp_f32 v172, v172
  v_mfma_f32_16x16x32_bf16 v[176:179], a[56:59], v[236:239], v[176:179]
  v_exp_f32 v173, v173
  v_mfma_f32_16x16x32_bf16 v[180:183], a[60:63], v[236:239], v[240:243]
  v_exp_f32 v174, v174
  v_mfma_f32_16x16x32_bf16 v[180:183], a[52:55], v[232:235], v[180:183]
  v_exp_f32 v175, v175
  v_mfma_f32_16x16x32_bf16 v[180:183], a[44:47], v[228:231], v[180:183]
  v_cvt_pk_bf16_f32 v194, v164, v165
  v_cvt_pk_bf16_f32 v195, v166, v167
  v_mfma_f32_16x16x32_bf16 v[180:183], a[36:39], v[224:227], v[180:183]
  v_cvt_pk_bf16_f32 v196, v168, v169
  v_cvt_pk_bf16_f32 v197, v170, v171
  v_mfma_f32_16x16x32_bf16 v[188:191], a[4:7], v[224:227], v[240:243]
  v_cvt_pk_bf16_f32 v198, v172, v173
  v_cvt_pk_bf16_f32 v199, v174, v175
  v_mfma_f32_16x16x32_bf16 v[188:191], a[12:15], v[228:231], v[188:191]
  v_cvt_pk_bf16_f32 v64, v64, v65
  v_cvt_pk_bf16_f32 v65, v66, v67
  v_mfma_f32_16x16x32_bf16 v[188:191], a[20:23], v[232:235], v[188:191]
  v_cvt_pk_bf16_f32 v66, v68, v69
  v_cvt_pk_bf16_f32 v67, v70, v71
  v_mfma_f32_16x16x32_bf16 v[188:191], a[28:31], v[236:239], v[188:191]
  buffer_store_dwordx4 v[64:67], v1, s[20:23], s30 offen offset:128 sc1 nt
  v_exp_f32 v176, v176
  v_pk_mul_f32 v[84:85], v[84:85], v[26:27] op_sel_hi:[1,0]
  v_pk_mul_f32 v[86:87], v[86:87], v[26:27] op_sel_hi:[1,0]
  v_exp_f32 v177, v177
  v_mfma_f32_16x16x32_bf16 v[184:187], a[24:27], v[236:239], v[240:243]
  v_exp_f32 v178, v178
  v_mfma_f32_16x16x32_bf16 v[184:187], a[16:19], v[232:235], v[184:187]
  v_exp_f32 v179, v179
  v_mfma_f32_16x16x32_bf16 v[184:187], a[8:11], v[228:231], v[184:187]
  v_exp_f32 v180, v180
  v_mfma_f32_16x16x32_bf16 v[184:187], a[0:3], v[224:227], v[184:187]
  v_exp_f32 v181, v181
  v_mfma_f32_16x16x32_bf16 v[40:43], a[160:163], v[192:195], v[40:43]
  v_exp_f32 v182, v182
  v_mfma_f32_16x16x32_bf16 v[40:43], a[192:195], v[196:199], v[40:43]
  v_exp_f32 v183, v183
  v_mfma_f32_16x16x32_bf16 v[44:47], a[164:167], v[192:195], v[44:47]
  v_exp_f32 v184, v184
  v_mfma_f32_16x16x32_bf16 v[44:47], a[196:199], v[196:199], v[44:47]
  v_exp_f32 v185, v185
  v_smfmac_f32_16x16x64_bf16 v[28:31], v[10:13], v[192:199], v0
  v_cvt_pk_bf16_f32 v200, v176, v177
  v_mfma_f32_16x16x32_bf16 v[56:59], a[168:171], v[192:195], v[56:59]
  v_exp_f32 v186, v186
  v_mfma_f32_16x16x32_bf16 v[56:59], a[200:203], v[196:199], v[56:59]
  v_exp_f32 v187, v187
  v_mfma_f32_16x16x32_bf16 v[60:63], a[172:175], v[192:195], v[60:63]
  v_exp_f32 v188, v188
  v_mfma_f32_16x16x32_bf16 v[60:63], a[204:207], v[196:199], v[60:63]
  v_exp_f32 v189, v189
  v_mfma_f32_16x16x32_bf16 v[72:75], a[176:179], v[192:195], v[72:75]
  v_exp_f32 v190, v190
  v_mfma_f32_16x16x32_bf16 v[72:75], a[208:211], v[196:199], v[72:75]
  v_exp_f32 v191, v191
  v_mfma_f32_16x16x32_bf16 v[76:79], a[180:183], v[192:195], v[76:79]
  v_cvt_pk_bf16_f32 v201, v178, v179
  v_cvt_pk_bf16_f32 v202, v180, v181
  v_mfma_f32_16x16x32_bf16 v[76:79], a[212:215], v[196:199], v[76:79]
  v_cvt_pk_bf16_f32 v203, v182, v183
  v_cvt_pk_bf16_f32 v204, v184, v185
  v_mfma_f32_16x16x32_bf16 v[88:91], a[184:187], v[192:195], v[88:91]
  v_cvt_pk_bf16_f32 v205, v186, v187
  v_cvt_pk_bf16_f32 v206, v188, v189
  v_cvt_pk_bf16_f32 v207, v190, v191
  v_mfma_f32_16x16x32_bf16 v[88:91], a[216:219], v[196:199], v[88:91]
  v_cvt_pk_bf16_f32 v80, v80, v81
  v_cvt_pk_bf16_f32 v81, v82, v83
  v_smfmac_f32_16x16x64_bf16 v[28:31], v[10:13], v[200:207], v0
  v_cvt_pk_bf16_f32 v82, v84, v85
  v_mfma_f32_16x16x32_bf16 v[92:95], a[188:191], v[192:195], v[92:95]
  v_cvt_pk_bf16_f32 v83, v86, v87
  v_add_f32 v17, v16, v17
  v_mfma_f32_16x16x32_bf16 v[92:95], a[220:223], v[196:199], v[92:95]
  buffer_store_dwordx4 v[80:83], v1, s[20:23], s30 offen offset:192 sc1 nt
  v_add_f32 v15, v15, v17
  v_cmp_nle_f32_e64 s[44:45], v15, s27
  v_add_f32 v21, v20, v21
  v_add_f32 v23, v22, v23
  v_mfma_f32_16x16x32_bf16 v[40:43], a[64:67], v[200:203], v[40:43]
  v_add_f32 v29, v28, v29
  v_add_f32 v30, v30, v31
  v_mfma_f32_16x16x32_bf16 v[40:43], a[96:99], v[204:207], v[40:43]
  v_add_f32 v29, v29, v30
  v_add_f32 v21, v21, v23
  v_mfma_f32_16x16x32_bf16 v[44:47], a[68:71], v[200:203], v[44:47]
  v_rcp_f32 v28, v29
  v_mfma_f32_16x16x32_bf16 v[44:47], a[100:103], v[204:207], v[44:47]
  v_cmp_nle_f32_e64 s[46:47], v21, s27
  v_add_f32 v27, v26, v27
  v_mfma_f32_16x16x32_bf16 v[56:59], a[72:75], v[200:203], v[56:59]
  v_mul_f32 v40, v28, v40
  v_mul_f32 v41, v28, v41
  v_mfma_f32_16x16x32_bf16 v[56:59], a[104:107], v[204:207], v[56:59]
  v_cvt_pk_bf16_f32 v40, v40, v41
  v_mul_f32 v42, v28, v42
  v_mfma_f32_16x16x32_bf16 v[60:63], a[76:79], v[200:203], v[60:63]
  v_mul_f32 v43, v28, v43
  v_cvt_pk_bf16_f32 v41, v42, v43
  v_mfma_f32_16x16x32_bf16 v[60:63], a[108:111], v[204:207], v[60:63]
  v_mul_f32 v44, v28, v44
  v_mul_f32 v45, v28, v45
  v_mfma_f32_16x16x32_bf16 v[72:75], a[80:83], v[200:203], v[72:75]
  v_cvt_pk_bf16_f32 v42, v44, v45
  v_mul_f32 v46, v28, v46
  v_mfma_f32_16x16x32_bf16 v[72:75], a[112:115], v[204:207], v[72:75]
  v_mul_f32 v47, v28, v47
  v_cvt_pk_bf16_f32 v43, v46, v47
  v_mfma_f32_16x16x32_bf16 v[76:79], a[84:87], v[200:203], v[76:79]
  v_mul_f32 v56, v28, v56
  v_mul_f32 v57, v28, v57
  v_mfma_f32_16x16x32_bf16 v[76:79], a[116:119], v[204:207], v[76:79]
  v_cvt_pk_bf16_f32 v56, v56, v57
  v_mul_f32 v58, v28, v58
  v_mfma_f32_16x16x32_bf16 v[88:91], a[88:91], v[200:203], v[88:91]
  v_mul_f32 v59, v28, v59
  v_cvt_pk_bf16_f32 v57, v58, v59
  v_mfma_f32_16x16x32_bf16 v[88:91], a[120:123], v[204:207], v[88:91]
  v_mul_f32 v60, v28, v60
  v_mul_f32 v61, v28, v61
  v_mfma_f32_16x16x32_bf16 v[92:95], a[92:95], v[200:203], v[92:95]
  v_cvt_pk_bf16_f32 v58, v60, v61
  v_mul_f32 v62, v28, v62
  v_mfma_f32_16x16x32_bf16 v[92:95], a[124:127], v[204:207], v[92:95]
  v_mul_f32 v63, v28, v63
  v_cvt_pk_bf16_f32 v59, v62, v63
  buffer_store_dwordx4 v[40:43], v1, s[20:23], s58 offen offset:0 sc1 nt
  buffer_store_dwordx4 v[56:59], v1, s[20:23], s58 offen offset:64 sc1 nt
  v_pk_mul_f32 v[72:73], v[72:73], v[28:29] op_sel_hi:[1,0]
  v_pk_mul_f32 v[74:75], v[74:75], v[28:29] op_sel_hi:[1,0]
  v_pk_mul_f32 v[76:77], v[76:77], v[28:29] op_sel_hi:[1,0]
  v_pk_mul_f32 v[78:79], v[78:79], v[28:29] op_sel_hi:[1,0]
  v_pk_mul_f32 v[88:89], v[88:89], v[28:29] op_sel_hi:[1,0]
  v_pk_mul_f32 v[90:91], v[90:91], v[28:29] op_sel_hi:[1,0]
  v_pk_mul_f32 v[92:93], v[92:93], v[28:29] op_sel_hi:[1,0]
  v_pk_mul_f32 v[94:95], v[94:95], v[28:29] op_sel_hi:[1,0]
  v_cvt_pk_bf16_f32 v72, v72, v73
  v_cvt_pk_bf16_f32 v73, v74, v75
  v_cvt_pk_bf16_f32 v74, v76, v77
  v_cvt_pk_bf16_f32 v75, v78, v79
  buffer_store_dwordx4 v[72:75], v1, s[20:23], s58 offen offset:128 sc1 nt
  v_cvt_pk_bf16_f32 v88, v88, v89
  v_cvt_pk_bf16_f32 v89, v90, v91
  v_cvt_pk_bf16_f32 v90, v92, v93
  v_cvt_pk_bf16_f32 v91, v94, v95
  buffer_store_dwordx4 v[88:91], v1, s[20:23], s58 offen offset:192 sc1 nt
  v_add_f32 v29, v28, v29
  v_add_f32 v27, v27, v29
  v_cmp_nle_f32_e64 s[48:49], v27, s27
L_slow:
  s_nop 4
  s_or_b64 s[50:51], s[44:45], s[46:47]
  s_or_b64 s[50:51], s[50:51], s[48:49]
  s_cbranch_scc1 L_slow_go
  s_endpgm
L_slow_go:
  s_mov_b32 s52, 0
  s_cmp_lg_u64 s[44:45], 0
  s_cselect_b32 s53, 1, 0
  s_or_b32 s52, s52, s53
  s_cmp_lg_u64 s[46:47], 0
  s_cselect_b32 s53, 2, 0
  s_or_b32 s52, s52, s53
  s_cmp_lg_u64 s[48:49], 0
  s_cselect_b32 s53, 4, 0
  s_or_b32 s52, s52, s53
  s_waitcnt vmcnt(0) lgkmcnt(0)
  v_mbcnt_lo_u32_b32 v0, -1, 0
  v_mbcnt_hi_u32_b32 v0, -1, v0
  v_and_b32 v21, 31, v0
  v_lshrrev_b32 v22, 5, v0
  v_lshlrev_b32 v1, 8, v21
  v_lshl_add_u32 v1, v22, 4, v1
  v_lshlrev_b32 v20, 10, v22
  v_bfe_u32 v23, v21, 4, 1
  v_lshl_add_u32 v20, v23, 5, v20
  v_bfe_u32 v23, v21, 2, 1
  v_lshl_add_u32 v20, v23, 4, v20
  v_bfe_u32 v23, v21, 3, 1
  v_lshl_add_u32 v20, v23, 3, v20
  v_and_b32 v23, 3, v21
  v_lshl_add_u32 v20, v23, 1, v20
  s_mov_b32 s53, 0
  s_mov_b32 s54, s28
L_slow_tile:
  s_bitcmp1_b32 s52, s53
  s_cbranch_scc0 L_slow_next
  s_waitcnt vmcnt(0)
  buffer_load_dwordx4 v[32:35], v1, s[8:11], s54 offen offset:0
  buffer_load_dwordx4 v[36:39], v1, s[8:11], s54 offen offset:32
  buffer_load_dwordx4 v[40:43], v1, s[8:11], s54 offen offset:64
  buffer_load_dwordx4 v[44:47], v1, s[8:11], s54 offen offset:96
  buffer_load_dwordx4 v[48:51], v1, s[8:11], s54 offen offset:128
  buffer_load_dwordx4 v[52:55], v1, s[8:11], s54 offen offset:160
  buffer_load_dwordx4 v[56:59], v1, s[8:11], s54 offen offset:192
  buffer_load_dwordx4 v[60:63], v1, s[8:11], s54 offen offset:224
  v_mov_b32 v14, 0xff800000
  s_mov_b32 s55, 0
L_slow_max:
  buffer_load_dwordx4 v[64:67], v1, s[12:15], s55 offen offset:0
  buffer_load_dwordx4 v[68:71], v1, s[12:15], s55 offen offset:32
  buffer_load_dwordx4 v[72:75], v1, s[12:15], s55 offen offset:64
  buffer_load_dwordx4 v[76:79], v1, s[12:15], s55 offen offset:96
  buffer_load_dwordx4 v[80:83], v1, s[12:15], s55 offen offset:128
  buffer_load_dwordx4 v[84:87], v1, s[12:15], s55 offen offset:160
  buffer_load_dwordx4 v[88:91], v1, s[12:15], s55 offen offset:192
  buffer_load_dwordx4 v[92:95], v1, s[12:15], s55 offen offset:224
  s_waitcnt vmcnt(0)
  v_mfma_f32_32x32x16_bf16 v[160:175], v[64:67], v[32:35], 0
  v_mfma_f32_32x32x16_bf16 v[160:175], v[68:71], v[36:39], v[160:175]
  v_mfma_f32_32x32x16_bf16 v[160:175], v[72:75], v[40:43], v[160:175]
  v_mfma_f32_32x32x16_bf16 v[160:175], v[76:79], v[44:47], v[160:175]
  v_mfma_f32_32x32x16_bf16 v[160:175], v[80:83], v[48:51], v[160:175]
  v_mfma_f32_32x32x16_bf16 v[160:175], v[84:87], v[52:55], v[160:175]
  v_mfma_f32_32x32x16_bf16 v[160:175], v[88:91], v[56:59], v[160:175]
  v_mfma_f32_32x32x16_bf16 v[160:175], v[92:95], v[60:63], v[160:175]
  s_nop 15
  v_max3_f32 v14, v14, v160, v161
  v_max3_f32 v14, v14, v162, v163
  v_max3_f32 v14, v14, v164, v165
  v_max3_f32 v14, v14, v166, v167
  v_max3_f32 v14, v14, v168, v169
  v_max3_f32 v14, v14, v170, v171
  v_max3_f32 v14, v14, v172, v173
  v_max3_f32 v14, v14, v174, v175
  s_add_u32 s55, s55, 8192
  s_cmp_lt_u32 s55, 98304
  s_cbranch_scc1 L_slow_max
  v_mov_b32 v18, v14
  s_nop 1
  v_permlane32_swap_b32 v14, v18
  v_max_f32 v14, v14, v18
  v_mov_b32 v11, 0
  v_mov_b32 v96, 0
  v_mov_b32 v97, 0
  v_mov_b32 v98, 0
  v_mov_b32 v99, 0
  v_mov_b32 v100, 0
  v_mov_b32 v101, 0
  v_mov_b32 v102, 0
  v_mov_b32 v103, 0
  v_mov_b32 v104, 0
  v_mov_b32 v105, 0
  v_mov_b32 v106, 0
  v_mov_b32 v107, 0
  v_mov_b32 v108, 0
  v_mov_b32 v109, 0
  v_mov_b32 v110, 0
  v_mov_b32 v111, 0
  v_mov_b32 v112, 0
  v_mov_b32 v113, 0
  v_mov_b32 v114, 0
  v_mov_b32 v115, 0
  v_mov_b32 v116, 0
  v_mov_b32 v117, 0
  v_mov_b32 v118, 0
  v_mov_b32 v119, 0
  v_mov_b32 v120, 0
  v_mov_b32 v121, 0
  v_mov_b32 v122, 0
  v_mov_b32 v123, 0
  v_mov_b32 v124, 0
  v_mov_b32 v125, 0
  v_mov_b32 v126, 0
  v_mov_b32 v127, 0
  v_mov_b32 v128, 0
  v_mov_b32 v129, 0
  v_mov_b32 v130, 0
  v_mov_b32 v131, 0
  v_mov_b32 v132, 0
  v_mov_b32 v133, 0
  v_mov_b32 v134, 0
  v_mov_b32 v135, 0
  v_mov_b32 v136, 0
  v_mov_b32 v137, 0
  v_mov_b32 v138, 0
  v_mov_b32 v139, 0
  v_mov_b32 v140, 0
  v_mov_b32 v141, 0
  v_mov_b32 v142, 0
  v_mov_b32 v143, 0
  v_mov_b32 v144, 0
  v_mov_b32 v145, 0
  v_mov_b32 v146, 0
  v_mov_b32 v147, 0
  v_mov_b32 v148, 0
  v_mov_b32 v149, 0
  v_mov_b32 v150, 0
  v_mov_b32 v151, 0
  v_mov_b32 v152, 0
  v_mov_b32 v153, 0
  v_mov_b32 v154, 0
  v_mov_b32 v155, 0
  v_mov_b32 v156, 0
  v_mov_b32 v157, 0
  v_mov_b32 v158, 0
  v_mov_b32 v159, 0
  s_mov_b32 s55, 0
L_slow_pv:
  buffer_load_dwordx4 v[64:67], v1, s[12:15], s55 offen offset:0
  buffer_load_dwordx4 v[68:71], v1, s[12:15], s55 offen offset:32
  buffer_load_dwordx4 v[72:75], v1, s[12:15], s55 offen offset:64
  buffer_load_dwordx4 v[76:79], v1, s[12:15], s55 offen offset:96
  buffer_load_dwordx4 v[80:83], v1, s[12:15], s55 offen offset:128
  buffer_load_dwordx4 v[84:87], v1, s[12:15], s55 offen offset:160
  buffer_load_dwordx4 v[88:91], v1, s[12:15], s55 offen offset:192
  buffer_load_dwordx4 v[92:95], v1, s[12:15], s55 offen offset:224
  s_waitcnt vmcnt(0)
  v_mfma_f32_32x32x16_bf16 v[160:175], v[64:67], v[32:35], 0
  v_mfma_f32_32x32x16_bf16 v[160:175], v[68:71], v[36:39], v[160:175]
  v_mfma_f32_32x32x16_bf16 v[160:175], v[72:75], v[40:43], v[160:175]
  v_mfma_f32_32x32x16_bf16 v[160:175], v[76:79], v[44:47], v[160:175]
  v_mfma_f32_32x32x16_bf16 v[160:175], v[80:83], v[48:51], v[160:175]
  v_mfma_f32_32x32x16_bf16 v[160:175], v[84:87], v[52:55], v[160:175]
  v_mfma_f32_32x32x16_bf16 v[160:175], v[88:91], v[56:59], v[160:175]
  v_mfma_f32_32x32x16_bf16 v[160:175], v[92:95], v[60:63], v[160:175]
  s_nop 15
  v_sub_f32 v160, v160, v14
  v_sub_f32 v161, v161, v14
  v_sub_f32 v162, v162, v14
  v_sub_f32 v163, v163, v14
  v_sub_f32 v164, v164, v14
  v_sub_f32 v165, v165, v14
  v_sub_f32 v166, v166, v14
  v_sub_f32 v167, v167, v14
  v_sub_f32 v168, v168, v14
  v_sub_f32 v169, v169, v14
  v_sub_f32 v170, v170, v14
  v_sub_f32 v171, v171, v14
  v_sub_f32 v172, v172, v14
  v_sub_f32 v173, v173, v14
  v_sub_f32 v174, v174, v14
  v_sub_f32 v175, v175, v14
  v_mul_f32 v160, s25, v160
  v_mul_f32 v161, s25, v161
  v_mul_f32 v162, s25, v162
  v_mul_f32 v163, s25, v163
  v_mul_f32 v164, s25, v164
  v_mul_f32 v165, s25, v165
  v_mul_f32 v166, s25, v166
  v_mul_f32 v167, s25, v167
  v_mul_f32 v168, s25, v168
  v_mul_f32 v169, s25, v169
  v_mul_f32 v170, s25, v170
  v_mul_f32 v171, s25, v171
  v_mul_f32 v172, s25, v172
  v_mul_f32 v173, s25, v173
  v_mul_f32 v174, s25, v174
  v_mul_f32 v175, s25, v175
  v_exp_f32 v160, v160
  v_exp_f32 v161, v161
  v_exp_f32 v162, v162
  v_exp_f32 v163, v163
  v_exp_f32 v164, v164
  v_exp_f32 v165, v165
  v_exp_f32 v166, v166
  v_exp_f32 v167, v167
  v_exp_f32 v168, v168
  v_exp_f32 v169, v169
  v_exp_f32 v170, v170
  v_exp_f32 v171, v171
  v_exp_f32 v172, v172
  v_exp_f32 v173, v173
  v_exp_f32 v174, v174
  v_exp_f32 v175, v175
  s_nop 1
  v_add_f32 v11, v11, v160
  v_add_f32 v11, v11, v161
  v_add_f32 v11, v11, v162
  v_add_f32 v11, v11, v163
  v_add_f32 v11, v11, v164
  v_add_f32 v11, v11, v165
  v_add_f32 v11, v11, v166
  v_add_f32 v11, v11, v167
  v_add_f32 v11, v11, v168
  v_add_f32 v11, v11, v169
  v_add_f32 v11, v11, v170
  v_add_f32 v11, v11, v171
  v_add_f32 v11, v11, v172
  v_add_f32 v11, v11, v173
  v_add_f32 v11, v11, v174
  v_add_f32 v11, v11, v175
  v_cvt_pk_bf16_f32 v192, v160, v161
  v_cvt_pk_bf16_f32 v193, v162, v163
  v_cvt_pk_bf16_f32 v194, v164, v165
  v_cvt_pk_bf16_f32 v195, v166, v167
  v_cvt_pk_bf16_f32 v196, v168, v169
  v_cvt_pk_bf16_f32 v197, v170, v171
  v_cvt_pk_bf16_f32 v198, v172, v173
  v_cvt_pk_bf16_f32 v199, v174, v175
  s_add_u32 s61, s55, 0
  buffer_load_ushort v200, v20, s[16:19], s61 offen offset:0
  buffer_load_ushort v201, v20, s[16:19], s61 offen offset:256
  buffer_load_ushort v202, v20, s[16:19], s61 offen offset:512
  buffer_load_ushort v203, v20, s[16:19], s61 offen offset:768
  buffer_load_ushort v204, v20, s[16:19], s61 offen offset:2048
  buffer_load_ushort v205, v20, s[16:19], s61 offen offset:2304
  buffer_load_ushort v206, v20, s[16:19], s61 offen offset:2560
  buffer_load_ushort v207, v20, s[16:19], s61 offen offset:2816
  buffer_load_ushort v208, v20, s[16:19], s61 offen offset:64
  buffer_load_ushort v209, v20, s[16:19], s61 offen offset:320
  buffer_load_ushort v210, v20, s[16:19], s61 offen offset:576
  buffer_load_ushort v211, v20, s[16:19], s61 offen offset:832
  buffer_load_ushort v212, v20, s[16:19], s61 offen offset:2112
  buffer_load_ushort v213, v20, s[16:19], s61 offen offset:2368
  buffer_load_ushort v214, v20, s[16:19], s61 offen offset:2624
  buffer_load_ushort v215, v20, s[16:19], s61 offen offset:2880
  buffer_load_ushort v216, v20, s[16:19], s61 offen offset:128
  buffer_load_ushort v217, v20, s[16:19], s61 offen offset:384
  buffer_load_ushort v218, v20, s[16:19], s61 offen offset:640
  buffer_load_ushort v219, v20, s[16:19], s61 offen offset:896
  buffer_load_ushort v220, v20, s[16:19], s61 offen offset:2176
  buffer_load_ushort v221, v20, s[16:19], s61 offen offset:2432
  buffer_load_ushort v222, v20, s[16:19], s61 offen offset:2688
  buffer_load_ushort v223, v20, s[16:19], s61 offen offset:2944
  buffer_load_ushort v224, v20, s[16:19], s61 offen offset:192
  buffer_load_ushort v225, v20, s[16:19], s61 offen offset:448
  buffer_load_ushort v226, v20, s[16:19], s61 offen offset:704
  buffer_load_ushort v227, v20, s[16:19], s61 offen offset:960
  buffer_load_ushort v228, v20, s[16:19], s61 offen offset:2240
  buffer_load_ushort v229, v20, s[16:19], s61 offen offset:2496
  buffer_load_ushort v230, v20, s[16:19], s61 offen offset:2752
  buffer_load_ushort v231, v20, s[16:19], s61 offen offset:3008
  s_waitcnt vmcnt(0)
  v_lshl_or_b32 v232, v201, 16, v200
  v_lshl_or_b32 v233, v203, 16, v202
  v_lshl_or_b32 v234, v205, 16, v204
  v_lshl_or_b32 v235, v207, 16, v206
  v_lshl_or_b32 v236, v209, 16, v208
  v_lshl_or_b32 v237, v211, 16, v210
  v_lshl_or_b32 v238, v213, 16, v212
  v_lshl_or_b32 v239, v215, 16, v214
  v_lshl_or_b32 v240, v217, 16, v216
  v_lshl_or_b32 v241, v219, 16, v218
  v_lshl_or_b32 v242, v221, 16, v220
  v_lshl_or_b32 v243, v223, 16, v222
  v_lshl_or_b32 v244, v225, 16, v224
  v_lshl_or_b32 v245, v227, 16, v226
  v_lshl_or_b32 v246, v229, 16, v228
  v_lshl_or_b32 v247, v231, 16, v230
  s_nop 1
  v_mfma_f32_32x32x16_bf16 v[96:111], v[232:235], v[192:195], v[96:111]
  v_mfma_f32_32x32x16_bf16 v[112:127], v[236:239], v[192:195], v[112:127]
  v_mfma_f32_32x32x16_bf16 v[128:143], v[240:243], v[192:195], v[128:143]
  v_mfma_f32_32x32x16_bf16 v[144:159], v[244:247], v[192:195], v[144:159]
  s_nop 7
  s_add_u32 s61, s55, 4096
  buffer_load_ushort v200, v20, s[16:19], s61 offen offset:0
  buffer_load_ushort v201, v20, s[16:19], s61 offen offset:256
  buffer_load_ushort v202, v20, s[16:19], s61 offen offset:512
  buffer_load_ushort v203, v20, s[16:19], s61 offen offset:768
  buffer_load_ushort v204, v20, s[16:19], s61 offen offset:2048
  buffer_load_ushort v205, v20, s[16:19], s61 offen offset:2304
  buffer_load_ushort v206, v20, s[16:19], s61 offen offset:2560
  buffer_load_ushort v207, v20, s[16:19], s61 offen offset:2816
  buffer_load_ushort v208, v20, s[16:19], s61 offen offset:64
  buffer_load_ushort v209, v20, s[16:19], s61 offen offset:320
  buffer_load_ushort v210, v20, s[16:19], s61 offen offset:576
  buffer_load_ushort v211, v20, s[16:19], s61 offen offset:832
  buffer_load_ushort v212, v20, s[16:19], s61 offen offset:2112
  buffer_load_ushort v213, v20, s[16:19], s61 offen offset:2368
  buffer_load_ushort v214, v20, s[16:19], s61 offen offset:2624
  buffer_load_ushort v215, v20, s[16:19], s61 offen offset:2880
  buffer_load_ushort v216, v20, s[16:19], s61 offen offset:128
  buffer_load_ushort v217, v20, s[16:19], s61 offen offset:384
  buffer_load_ushort v218, v20, s[16:19], s61 offen offset:640
  buffer_load_ushort v219, v20, s[16:19], s61 offen offset:896
  buffer_load_ushort v220, v20, s[16:19], s61 offen offset:2176
  buffer_load_ushort v221, v20, s[16:19], s61 offen offset:2432
  buffer_load_ushort v222, v20, s[16:19], s61 offen offset:2688
  buffer_load_ushort v223, v20, s[16:19], s61 offen offset:2944
  buffer_load_ushort v224, v20, s[16:19], s61 offen offset:192
  buffer_load_ushort v225, v20, s[16:19], s61 offen offset:448
  buffer_load_ushort v226, v20, s[16:19], s61 offen offset:704
  buffer_load_ushort v227, v20, s[16:19], s61 offen offset:960
  buffer_load_ushort v228, v20, s[16:19], s61 offen offset:2240
  buffer_load_ushort v229, v20, s[16:19], s61 offen offset:2496
  buffer_load_ushort v230, v20, s[16:19], s61 offen offset:2752
  buffer_load_ushort v231, v20, s[16:19], s61 offen offset:3008
  s_waitcnt vmcnt(0)
  v_lshl_or_b32 v232, v201, 16, v200
  v_lshl_or_b32 v233, v203, 16, v202
  v_lshl_or_b32 v234, v205, 16, v204
  v_lshl_or_b32 v235, v207, 16, v206
  v_lshl_or_b32 v236, v209, 16, v208
  v_lshl_or_b32 v237, v211, 16, v210
  v_lshl_or_b32 v238, v213, 16, v212
  v_lshl_or_b32 v239, v215, 16, v214
  v_lshl_or_b32 v240, v217, 16, v216
  v_lshl_or_b32 v241, v219, 16, v218
  v_lshl_or_b32 v242, v221, 16, v220
  v_lshl_or_b32 v243, v223, 16, v222
  v_lshl_or_b32 v244, v225, 16, v224
  v_lshl_or_b32 v245, v227, 16, v226
  v_lshl_or_b32 v246, v229, 16, v228
  v_lshl_or_b32 v247, v231, 16, v230
  s_nop 1
  v_mfma_f32_32x32x16_bf16 v[96:111], v[232:235], v[196:199], v[96:111]
  v_mfma_f32_32x32x16_bf16 v[112:127], v[236:239], v[196:199], v[112:127]
  v_mfma_f32_32x32x16_bf16 v[128:143], v[240:243], v[196:199], v[128:143]
  v_mfma_f32_32x32x16_bf16 v[144:159], v[244:247], v[196:199], v[144:159]
  s_nop 7
  s_add_u32 s55, s55, 8192
  s_cmp_lt_u32 s55, 98304
  s_cbranch_scc1 L_slow_pv
  s_nop 15
  v_mov_b32 v18, v11
  s_nop 1
  v_permlane32_swap_b32 v11, v18
  v_add_f32 v11, v11, v18
  v_rcp_f32 v11, v11
  s_nop 1
  v_mul_f32 v96, v11, v96
  v_mul_f32 v97, v11, v97
  v_mul_f32 v98, v11, v98
  v_mul_f32 v99, v11, v99
  v_mul_f32 v100, v11, v100
  v_mul_f32 v101, v11, v101
  v_mul_f32 v102, v11, v102
  v_mul_f32 v103, v11, v103
  v_cvt_pk_bf16_f32 v32, v96, v97
  v_cvt_pk_bf16_f32 v33, v98, v99
  v_cvt_pk_bf16_f32 v34, v100, v101
  v_cvt_pk_bf16_f32 v35, v102, v103
  buffer_store_dwordx4 v[32:35], v1, s[20:23], s54 offen offset:0
  v_mul_f32 v104, v11, v104
  v_mul_f32 v105, v11, v105
  v_mul_f32 v106, v11, v106
  v_mul_f32 v107, v11, v107
  v_mul_f32 v108, v11, v108
  v_mul_f32 v109, v11, v109
  v_mul_f32 v110, v11, v110
  v_mul_f32 v111, v11, v111
  v_cvt_pk_bf16_f32 v36, v104, v105
  v_cvt_pk_bf16_f32 v37, v106, v107
  v_cvt_pk_bf16_f32 v38, v108, v109
  v_cvt_pk_bf16_f32 v39, v110, v111
  buffer_store_dwordx4 v[36:39], v1, s[20:23], s54 offen offset:32
  v_mul_f32 v112, v11, v112
  v_mul_f32 v113, v11, v113
  v_mul_f32 v114, v11, v114
  v_mul_f32 v115, v11, v115
  v_mul_f32 v116, v11, v116
  v_mul_f32 v117, v11, v117
  v_mul_f32 v118, v11, v118
  v_mul_f32 v119, v11, v119
  v_cvt_pk_bf16_f32 v40, v112, v113
  v_cvt_pk_bf16_f32 v41, v114, v115
  v_cvt_pk_bf16_f32 v42, v116, v117
  v_cvt_pk_bf16_f32 v43, v118, v119
  buffer_store_dwordx4 v[40:43], v1, s[20:23], s54 offen offset:64
  v_mul_f32 v120, v11, v120
  v_mul_f32 v121, v11, v121
  v_mul_f32 v122, v11, v122
  v_mul_f32 v123, v11, v123
  v_mul_f32 v124, v11, v124
  v_mul_f32 v125, v11, v125
  v_mul_f32 v126, v11, v126
  v_mul_f32 v127, v11, v127
  v_cvt_pk_bf16_f32 v44, v120, v121
  v_cvt_pk_bf16_f32 v45, v122, v123
  v_cvt_pk_bf16_f32 v46, v124, v125
  v_cvt_pk_bf16_f32 v47, v126, v127
  buffer_store_dwordx4 v[44:47], v1, s[20:23], s54 offen offset:96
  v_mul_f32 v128, v11, v128
  v_mul_f32 v129, v11, v129
  v_mul_f32 v130, v11, v130
  v_mul_f32 v131, v11, v131
  v_mul_f32 v132, v11, v132
  v_mul_f32 v133, v11, v133
  v_mul_f32 v134, v11, v134
  v_mul_f32 v135, v11, v135
  v_cvt_pk_bf16_f32 v48, v128, v129
  v_cvt_pk_bf16_f32 v49, v130, v131
  v_cvt_pk_bf16_f32 v50, v132, v133
  v_cvt_pk_bf16_f32 v51, v134, v135
  buffer_store_dwordx4 v[48:51], v1, s[20:23], s54 offen offset:128
  v_mul_f32 v136, v11, v136
  v_mul_f32 v137, v11, v137
  v_mul_f32 v138, v11, v138
  v_mul_f32 v139, v11, v139
  v_mul_f32 v140, v11, v140
  v_mul_f32 v141, v11, v141
  v_mul_f32 v142, v11, v142
  v_mul_f32 v143, v11, v143
  v_cvt_pk_bf16_f32 v52, v136, v137
  v_cvt_pk_bf16_f32 v53, v138, v139
  v_cvt_pk_bf16_f32 v54, v140, v141
  v_cvt_pk_bf16_f32 v55, v142, v143
  buffer_store_dwordx4 v[52:55], v1, s[20:23], s54 offen offset:160
  v_mul_f32 v144, v11, v144
  v_mul_f32 v145, v11, v145
  v_mul_f32 v146, v11, v146
  v_mul_f32 v147, v11, v147
  v_mul_f32 v148, v11, v148
  v_mul_f32 v149, v11, v149
  v_mul_f32 v150, v11, v150
  v_mul_f32 v151, v11, v151
  v_cvt_pk_bf16_f32 v56, v144, v145
  v_cvt_pk_bf16_f32 v57, v146, v147
  v_cvt_pk_bf16_f32 v58, v148, v149
  v_cvt_pk_bf16_f32 v59, v150, v151
  buffer_store_dwordx4 v[56:59], v1, s[20:23], s54 offen offset:192
  v_mul_f32 v152, v11, v152
  v_mul_f32 v153, v11, v153
  v_mul_f32 v154, v11, v154
  v_mul_f32 v155, v11, v155
  v_mul_f32 v156, v11, v156
  v_mul_f32 v157, v11, v157
  v_mul_f32 v158, v11, v158
  v_mul_f32 v159, v11, v159
  v_cvt_pk_bf16_f32 v60, v152, v153
  v_cvt_pk_bf16_f32 v61, v154, v155
  v_cvt_pk_bf16_f32 v62, v156, v157
  v_cvt_pk_bf16_f32 v63, v158, v159
  buffer_store_dwordx4 v[60:63], v1, s[20:23], s54 offen offset:224
L_slow_next:
  s_add_u32 s53, s53, 1
  s_add_u32 s54, s54, 32768
  s_cmp_lt_u32 s53, 3
  s_cbranch_scc1 L_slow_tile
L_end:
  s_endpgm
.section .rodata,"a"
.p2align 6
.amdhsa_kernel standalone__gqa_softmax__near_ridge_kernel
  .amdhsa_next_free_vgpr 512
  .amdhsa_next_free_sgpr 102
  .amdhsa_accum_offset 256
  .amdhsa_group_segment_fixed_size 0
  .amdhsa_kernarg_size 48
  .amdhsa_user_sgpr_count 2
  .amdhsa_user_sgpr_kernarg_segment_ptr 1
  .amdhsa_system_sgpr_workgroup_id_x 1
.end_amdhsa_kernel
```
